```python
import torch

def _softmax(x, axis=-1):
    return torch.softmax(x, dim=axis)
def _gelu(x):
    return torch.nn.functional.gelu(x, approximate="tanh")
def _silu(x):
    return torch.nn.functional.silu(x)
def _sigmoid(x):
    return torch.sigmoid(x)
def _layernorm(x, axis=-1, eps=1e-5):
    m = x.mean(dim=axis, keepdim=True)
    v = x.var(dim=axis, keepdim=True, unbiased=False)
    return (x - m) / torch.sqrt(v + eps)
def _scatter_add(tgt, idx, src, axis=0):
    return tgt.clone().index_add_(axis, idx, src)
def _segment_sum(src, seg, n):
    out = torch.zeros((n,) + src.shape[1:], dtype=src.dtype)
    return out.index_add_(0, seg, src)
def _pad(x, pw):
    flat = tuple(v for pair in reversed(pw) for v in pair)
    return torch.nn.functional.pad(x, flat)

kernel_name = 'concat_heads__gqa_block_cached__compressed_kv_cla__decode'

def setup_inputs():

    _w = (lambda a: (lambda t: t.to(torch.bfloat16) if t.is_floating_point() else t)(torch.as_tensor(a)))
    def _A_setup():
        B, Sq, D = 1, 1, 448
        Hq, Hkv, Sk, Dh = 16, 8, 8192, 256
        assert Hq % Hkv == 0, (Hq, Hkv)
        return {
            "x": _w((lambda *s: torch.randn(*s, dtype=torch.bfloat16) * 1.6)(B, Sq, D)),
            "k_cache": _w((lambda *s: torch.randn(*s, dtype=torch.bfloat16) * 1.6)(B, Hkv, Sk, Dh)),
            "v_cache": _w((lambda *s: torch.randn(*s, dtype=torch.bfloat16) * 0.05)(B, Hkv, Sk, Dh)),
            "wq": _w((lambda *s: torch.randn(*s, dtype=torch.bfloat16) * 1.6)(D, Hq * Dh) * (D ** -0.5)),
            "wo": _w((lambda *s: torch.randn(*s, dtype=torch.bfloat16) * 0.05)(Hq * Dh, D) * ((Hq * Dh) ** -0.5)),
        }
    _A_in = _A_setup()

    def _B_setup():
        B, H, Sq, Sk, D, M = 1, 16, 1, 8192, 256, 448
        Dc = 4 * D
        return {
            "x": _w((lambda *s: torch.randn(*s, dtype=torch.bfloat16) * 3.2)(B, Sq, M)),
            "c_kv": _w((lambda *s: torch.randn(*s, dtype=torch.bfloat16) * 0.1)(B, Sk, Dc)),
            "w_q": _w((lambda *s: torch.randn(*s, dtype=torch.bfloat16) * 6.4)(M, H, D) * (M ** -0.5)),
            "w_uk": _w((lambda *s: torch.randn(*s, dtype=torch.bfloat16) * 6.4)(Dc, H, D) * (Dc ** -0.5)),
            "w_uv": _w((lambda *s: torch.randn(*s, dtype=torch.bfloat16) * 0.1)(Dc, H, D) * (Dc ** -0.5)),
            "w_o": _w((lambda *s: torch.randn(*s, dtype=torch.bfloat16) * 0.1)(H, D, M) * ((H * D) ** -0.5)),
        }
    _B_in = _B_setup()

    return {
        "A_x": _A_in["x"],
        "A_k_cache": _A_in["k_cache"],
        "A_v_cache": _A_in["v_cache"],
        "A_wq": _A_in["wq"],
        "A_wo": _A_in["wo"],
        "B_x": _B_in["x"],
        "B_c_kv": _B_in["c_kv"],
        "B_w_q": _B_in["w_q"],
        "B_w_uk": _B_in["w_uk"],
        "B_w_uv": _B_in["w_uv"],
        "B_w_o": _B_in["w_o"],
    }

def reference(A_x, A_k_cache, A_v_cache, A_wq, A_wo, B_x, B_c_kv, B_w_q, B_w_uk, B_w_uv, B_w_o):
    def _A_ref(x, k_cache, v_cache, wq, wo):
        B, Sq, D = x.shape
        Hq, Dh = 16, 256
        Hkv = k_cache.shape[1]
        rep = Hq // Hkv
        q = (lambda x, *d: x.permute(*d))((x @ wq).reshape(B, Sq, Hq, Dh), 0, 2, 1, 3)
        k = (lambda x, n, axis: torch.repeat_interleave(x, n, dim=axis))(k_cache, rep, axis=1)
        v = (lambda x, n, axis: torch.repeat_interleave(x, n, dim=axis))(v_cache, rep, axis=1)
        scores = torch.einsum("bhqd,bhkd->bhqk", q, k) * (Dh ** -0.5)
        p = _softmax(scores, axis=-1)
        o = torch.einsum("bhqk,bhkd->bhqd", p, v)
        return (lambda x, *d: x.permute(*d))(o, 0, 2, 1, 3).reshape(B, Sq, Hq * Dh) @ wo

    def _B_ref(x, c_kv, w_q, w_uk, w_uv, w_o):
        B, Sq, M = x.shape[0], x.shape[1], x.shape[2]
        Sk = c_kv.shape[1]
        H, D = w_q.shape[1], w_q.shape[2]
        q = torch.einsum("bqm,mhd->bhqd", x, w_q)
        k = torch.einsum("bkc,chd->bhkd", c_kv, w_uk)
        v = torch.einsum("bkc,chd->bhkd", c_kv, w_uv)
        scores = torch.einsum("bhqd,bhkd->bhqk", q, k) * (D ** -0.5)
        off = Sk - Sq
        qi = torch.arange(Sq)[:, None]
        kj = torch.arange(Sk)[None, :]
        cmask = kj <= (qi + off)
        scores = torch.where(cmask[None, None], scores, -1e9)
        p = _softmax(scores, axis=-1)
        ctx = torch.einsum("bhqk,bhkd->bhqd", p, v)
        return torch.einsum("bhqd,hdm->bqm", ctx, w_o)

    a = _A_ref(A_x, A_k_cache, A_v_cache, A_wq, A_wo)
    b = _B_ref(B_x, B_c_kv, B_w_q, B_w_uk, B_w_uv, B_w_o)
    return torch.concatenate([a, b], axis=-1)
```

```asm
; @launch grid=(512,1,1) block=(256,1,1) lds=81920
.amdgcn_target "amdgcn-amd-amdhsa--gfx950"
.text
.globl concat_heads__gqa_block_cached__compressed_kv_cla__decode_kernel
.p2align 8
.type concat_heads__gqa_block_cached__compressed_kv_cla__decode_kernel,@function
concat_heads__gqa_block_cached__compressed_kv_cla__decode_kernel:
  s_cmp_ge_u32 s2, 512
  s_cbranch_scc1 L_end
  s_load_dwordx16 s[16:31], s[0:1], 0
  s_load_dwordx8 s[32:39], s[0:1], 64
  s_load_dwordx4 s[40:43], s[0:1], 96
  s_memrealtime s[4:5]
  v_lshrrev_b32 v7, 6, v0
  v_and_b32 v1, 63, v0
  v_readfirstlane_b32 s3, v7
  v_lshlrev_b32 v6, 4, v1
  s_cmp_ge_u32 s2, 256
  s_nop 1
  s_cbranch_scc1 L_A
  s_setprio 2
  s_cmp_ge_u32 s2, 128
  s_cbranch_scc1 L_X
  s_and_b32 s100, s2, 7
  s_lshl_b32 s100, s100, 3
  s_bfe_u32 s6, s2, 0x30003
  s_add_u32 s100, s100, s6
  s_lshr_b32 s101, s2, 6
  s_mul_i32 s96, s101, 224
  s_mul_i32 s6, s3, 56
  s_add_u32 s96, s96, s6
  s_lshl_b32 s97, s96, 1
  s_lshl_b32 s96, s96, 13
  s_lshl_b32 s6, s100, 7
  s_add_u32 s96, s96, s6
  v_lshrrev_b32 v200, 3, v1
  v_mul_u32_u24 v240, 14, v200
  v_and_b32 v240, 0x7c, v240
  v_mul_u32_u24 v241, 57344, v200
  v_and_b32 v201, 7, v1
  v_lshl_add_u32 v241, v201, 4, v241
  v_mov_b32 v247, 0
  v_mov_b32 v249, 0
  s_lshr_b32 s12, s2, 3
  s_and_b32 s13, s2, 7
  s_lshl_b32 s14, s13, 8
  s_mul_i32 s6, s12, 2176
  s_add_u32 s14, s14, s6
  s_add_u32 s14, s14, 131072
  v_mov_b32 v204, -1
  v_mov_b32 v205, -1
  v_mov_b32 v206, -1
  v_mov_b32 v207, -1
  s_waitcnt lgkmcnt(0)
  s_or_b32 s77, s4, 1
  s_mov_b32 s44, s42
  s_mov_b32 s45, s43
  s_mov_b32 s46, 268435456
  s_mov_b32 s47, 0x20000
  s_mov_b32 s48, s40
  s_mov_b32 s49, s41
  s_mov_b32 s50, 256
  s_mov_b32 s51, 0x20000
  s_mov_b32 s52, s26
  s_mov_b32 s53, s27
  s_mov_b32 s54, 896
  s_mov_b32 s55, 0x20000
  s_mov_b32 s56, s30
  s_mov_b32 s57, s31
  s_mov_b32 s58, 3670016
  s_mov_b32 s59, 0x20000
  s_cmp_lg_u32 s3, 3
  s_cbranch_scc1 Le0_1
  s_cmp_ge_u32 s2, 8
  s_cbranch_scc1 Lcas_2
  s_mov_b32 s80, s77
  s_mov_b32 s81, 0
  s_atomic_cmpswap s[80:81], s[40:41], 0 glc
Lcas_2:
  s_mov_b32 exec_lo, 0xffff
  s_mov_b32 exec_hi, 0x0
  buffer_store_dwordx4 v[204:207], v6, s[44:47], s14 offen sc1
  s_mov_b64 exec, -1
Le0_1:
  buffer_load_dwordx4 v[8:11], v240, s[52:55], s97 offen
  s_add_u32 s79, s96, 0
  buffer_load_dwordx4 v[16:19], v241, s[56:59], s79 offen nt
  s_add_u32 s79, s96, 8192
  buffer_load_dwordx4 v[20:23], v241, s[56:59], s79 offen nt
  s_add_u32 s79, s96, 16384
  buffer_load_dwordx4 v[24:27], v241, s[56:59], s79 offen nt
  s_add_u32 s79, s96, 24576
  buffer_load_dwordx4 v[28:31], v241, s[56:59], s79 offen nt
  s_add_u32 s79, s96, 32768
  buffer_load_dwordx4 v[32:35], v241, s[56:59], s79 offen nt
  s_add_u32 s79, s96, 40960
  buffer_load_dwordx4 v[36:39], v241, s[56:59], s79 offen nt
  s_add_u32 s79, s96, 49152
  buffer_load_dwordx4 v[40:43], v241, s[56:59], s79 offen nt
  s_mov_b32 s68, s32
  s_mov_b32 s69, s33
  s_mov_b32 s70, 8388608
  s_mov_b32 s71, 0x20000
  s_mov_b32 s72, s34
  s_mov_b32 s73, s35
  s_mov_b32 s74, 8388608
  s_mov_b32 s75, 0x20000
  v_lshrrev_b32 v202, 4, v1
  v_lshrrev_b32 v251, 4, v0
  v_lshlrev_b32 v251, 4, v251
  v_bfe_u32 v250, v1, 2, 2
  v_lshlrev_b32 v250, 16, v250
  v_lshl_add_u32 v250, v202, 6, v250
  v_and_b32 v203, 3, v1
  v_lshl_add_u32 v250, v203, 4, v250
  s_lshl_b32 s15, s13, 20
  s_lshl_b32 s5, s3, 18
  s_add_u32 s15, s15, s5
  s_lshl_b32 s5, s12, 9
  s_add_u32 s15, s15, s5
  v_and_b32 v212, 1, v1
  v_lshlrev_b32 v212, 4, v212
  v_mov_b32 v213, 0xffff
  v_lshlrev_b32 v212, v212, v213
  v_bfe_u32 v213, v1, 1, 2
  v_cmp_eq_u32 vcc, 0, v213
  s_nop 1
  v_cndmask_b32 v2, 0, v212, vcc
  v_cmp_eq_u32 vcc, 1, v213
  s_nop 1
  v_cndmask_b32 v3, 0, v212, vcc
  v_cmp_eq_u32 vcc, 2, v213
  s_nop 1
  v_cndmask_b32 v4, 0, v212, vcc
  v_cmp_eq_u32 vcc, 3, v213
  s_nop 1
  v_cndmask_b32 v5, 0, v212, vcc
  s_lshl_b32 s100, s100, 9
  s_lshl_b32 s101, s101, 15
  s_add_u32 s100, s100, s101
  v_bfe_u32 v200, v1, 3, 1
  v_cmp_eq_u32 vcc, 1, v200
  v_mov_b32 v208, 0x01000100
  v_mov_b32 v209, 0x03020302
  v_mov_b32 v210, 0x05040504
  v_cndmask_b32 v242, v208, v209, vcc
  v_cndmask_b32 v243, v209, v210, vcc
  s_lshl_b32 s5, s3, 10
  v_add_u32 v244, s5, v6
  v_and_b32 v203, 3, v1
  v_lshrrev_b32 v245, 5, v1
  v_lshlrev_b32 v245, 11, v245
  v_bfe_u32 v200, v1, 1, 1
  v_lshl_add_u32 v245, v200, 8, v245
  v_bfe_u32 v200, v1, 2, 3
  v_lshl_add_u32 v245, v200, 4, v245
  v_and_b32 v200, 1, v1
  v_lshl_add_u32 v245, v200, 3, v245
  s_add_u32 s79, s15, 0
  s_waitcnt vmcnt(7)
  buffer_load_dwordx4 v[72:75], v250, s[68:71], s79 offen offset:0 nt
  s_add_u32 s79, s15, 0
  s_waitcnt vmcnt(7)
  buffer_load_dwordx4 v[76:79], v250, s[68:71], s79 offen offset:256 nt
  s_add_u32 s79, s15, 8192
  s_waitcnt vmcnt(7)
  buffer_load_dwordx4 v[80:83], v250, s[68:71], s79 offen offset:0 nt
  s_add_u32 s79, s15, 8192
  s_waitcnt vmcnt(7)
  buffer_load_dwordx4 v[84:87], v250, s[68:71], s79 offen offset:256 nt
  s_cmp_lg_u32 s3, 3
  s_cbranch_scc1 Lel_3
  s_load_dword s76, s[40:41], 0
Lel_3:
  s_add_u32 s79, s15, 16384
  s_waitcnt vmcnt(7)
  buffer_load_dwordx4 v[88:91], v250, s[68:71], s79 offen offset:0 nt
  s_add_u32 s79, s15, 16384
  s_waitcnt vmcnt(7)
  buffer_load_dwordx4 v[92:95], v250, s[68:71], s79 offen offset:256 nt
  s_add_u32 s79, s15, 24576
  s_waitcnt vmcnt(7)
  buffer_load_dwordx4 v[96:99], v250, s[68:71], s79 offen offset:0 nt
  s_waitcnt vmcnt(7)
  v_perm_b32 v208, v8, v8, v242
  v_and_b32 v200, v208, v2
  v_and_b32 v201, v208, v3
  v_and_b32 v202, v208, v4
  v_and_b32 v203, v208, v5
  s_nop 1
  v_mfma_f32_16x16x32_bf16 v[212:215], v[200:203], v[16:19], 0
  v_perm_b32 v208, v9, v8, v243
  v_and_b32 v204, v208, v2
  v_and_b32 v205, v208, v3
  v_and_b32 v206, v208, v4
  v_and_b32 v207, v208, v5
  s_nop 1
  v_mfma_f32_16x16x32_bf16 v[212:215], v[204:207], v[20:23], v[212:215]
  v_perm_b32 v208, v9, v9, v242
  v_and_b32 v200, v208, v2
  v_and_b32 v201, v208, v3
  v_and_b32 v202, v208, v4
  v_and_b32 v203, v208, v5
  s_nop 1
  v_mfma_f32_16x16x32_bf16 v[212:215], v[200:203], v[24:27], v[212:215]
  v_perm_b32 v208, v10, v9, v243
  v_and_b32 v204, v208, v2
  v_and_b32 v205, v208, v3
  v_and_b32 v206, v208, v4
  v_and_b32 v207, v208, v5
  s_nop 1
  v_mfma_f32_16x16x32_bf16 v[212:215], v[204:207], v[28:31], v[212:215]
  v_perm_b32 v208, v10, v10, v242
  v_and_b32 v200, v208, v2
  v_and_b32 v201, v208, v3
  v_and_b32 v202, v208, v4
  v_and_b32 v203, v208, v5
  s_nop 1
  v_mfma_f32_16x16x32_bf16 v[212:215], v[200:203], v[32:35], v[212:215]
  v_perm_b32 v208, v11, v10, v243
  v_and_b32 v204, v208, v2
  v_and_b32 v205, v208, v3
  v_and_b32 v206, v208, v4
  v_and_b32 v207, v208, v5
  s_nop 1
  v_mfma_f32_16x16x32_bf16 v[212:215], v[204:207], v[36:39], v[212:215]
  v_perm_b32 v208, v11, v11, v242
  v_and_b32 v200, v208, v2
  v_and_b32 v201, v208, v3
  v_and_b32 v202, v208, v4
  v_and_b32 v203, v208, v5
  s_nop 1
  v_mfma_f32_16x16x32_bf16 v[212:215], v[200:203], v[40:43], v[212:215]
  s_cmp_lg_u32 s3, 3
  s_nop 5
  s_cbranch_scc1 Le1_4
  s_waitcnt lgkmcnt(0)
  s_cmp_eq_u32 s76, 0
  s_cbranch_scc1 Lef_6
  s_sub_u32 s5, s77, s76
  s_add_u32 s5, s5, 800
  s_cmp_lt_u32 s5, 1600
  s_cbranch_scc1 Leo_5
Lef_6:
  v_mov_b32 v248, 0
  s_mov_b32 s78, 100000
Lge_7:
  v_readfirstlane_b32 s76, v248
  s_nop 0
  s_cmp_lg_u32 s76, 0
  s_nop 1
  s_cbranch_scc1 Lged_8
  buffer_load_dword v248, v247, s[48:51], 0 offen sc1
  s_waitcnt vmcnt(0)
  s_sub_u32 s78, s78, 1
  s_cmp_lg_u32 s78, 0
  s_cbranch_scc1 Lge_7
Lged_8:
Leo_5:
  v_mov_b32 v248, s76
  ds_write_b32 v247, v248 offset:10240
Le1_4:
  ds_write_b128 v244, v[212:215] offset:0
  s_waitcnt lgkmcnt(0)
  s_barrier
  s_cmp_lg_u32 s3, 3
  s_cbranch_scc1 Lred_9
  ds_read_b64 v[200:201], v245 offset:0
  ds_read_b64 v[202:203], v245 offset:640
  ds_read_b64 v[204:205], v245 offset:1024
  ds_read_b64 v[206:207], v245 offset:1664
  s_add_u32 s5, s100, 0
  v_mov_b32 v209, s76
  v_mov_b32 v211, s76
  s_waitcnt lgkmcnt(0)
  v_pk_add_f32 v[200:201], v[200:201], v[202:203]
  v_pk_add_f32 v[204:205], v[204:205], v[206:207]
  v_pk_add_f32 v[200:201], v[200:201], v[204:205]
  v_mov_b64 v[202:203], v[200:201]
  s_nop 1
  v_permlane32_swap_b32 v200, v202
  v_permlane32_swap_b32 v201, v203
  v_add_f32 v208, v200, v202
  v_add_f32 v210, v201, v203
  s_mov_b32 exec_lo, 0xffffffff
  s_mov_b32 exec_hi, 0x0
  buffer_store_dwordx4 v[208:211], v6, s[44:47], s5 offen sc1
  s_lshl_b32 s5, s2, 2
  s_add_u32 s5, s5, 184320
  s_mov_b32 exec_lo, 0x1
  s_mov_b32 exec_hi, 0x0
  buffer_store_dword v209, v247, s[44:47], s5 offen sc1
  s_mov_b64 exec, -1
Lred_9:
  ds_read_b32 v248, v247 offset:10240
  s_add_u32 s79, s15, 24576
  s_waitcnt vmcnt(7)
  buffer_load_dwordx4 v[100:103], v250, s[68:71], s79 offen offset:256 nt
  s_add_u32 s79, s15, 32768
  s_waitcnt vmcnt(7)
  buffer_load_dwordx4 v[104:107], v250, s[68:71], s79 offen offset:0 nt
  s_add_u32 s79, s15, 32768
  s_waitcnt vmcnt(7)
  buffer_load_dwordx4 v[108:111], v250, s[68:71], s79 offen offset:256 nt
  s_add_u32 s79, s15, 40960
  s_waitcnt vmcnt(7)
  buffer_load_dwordx4 v[112:115], v250, s[68:71], s79 offen offset:0 nt
  s_add_u32 s79, s15, 40960
  s_waitcnt vmcnt(7)
  buffer_load_dwordx4 v[116:119], v250, s[68:71], s79 offen offset:256 nt
  s_add_u32 s79, s15, 49152
  s_waitcnt vmcnt(7)
  buffer_load_dwordx4 v[120:123], v250, s[68:71], s79 offen offset:0 nt
  s_add_u32 s79, s15, 49152
  s_waitcnt vmcnt(7)
  buffer_load_dwordx4 v[124:127], v250, s[68:71], s79 offen offset:256 nt
  s_add_u32 s79, s15, 57344
  s_waitcnt vmcnt(7)
  buffer_load_dwordx4 v[128:131], v250, s[68:71], s79 offen offset:0 nt
  s_add_u32 s79, s15, 57344
  s_waitcnt vmcnt(7)
  buffer_load_dwordx4 v[132:135], v250, s[68:71], s79 offen offset:256 nt
  s_waitcnt lgkmcnt(0)
  v_readfirstlane_b32 s76, v248
  s_cmp_ge_u32 s3, 2
  s_nop 2
  s_cbranch_scc1 Lqb_10
  s_lshl_b32 s6, s12, 11
  s_lshl_b32 s5, s3, 10
  s_add_u32 s6, s6, s5
  s_add_u32 s6, s6, 0
  v_lshlrev_b32 v220, 2, v0
  v_add_u32 v220, 0x2000, v220
  s_add_u32 s7, s6, 0x8000
  s_mov_b32 s78, 100000
Lpoll_11:
  buffer_load_dwordx4 v[200:203], v6, s[44:47], s6 offen offset:0 sc1
  buffer_load_dwordx4 v[204:207], v6, s[44:47], s7 offen offset:0 sc1
Lpw_12:
  s_waitcnt vmcnt(0)
  v_bitop3_b32 v208, v201, v203, s76 bitop3:0x7e
  v_bitop3_b32 v209, v205, v207, s76 bitop3:0x7e
  v_or3_b32 v208, v208, v209, v209
  v_cmp_ne_u32 vcc, 0, v208
  s_nop 0
  s_cmp_eq_u64 vcc, 0
  s_nop 1
  s_cbranch_scc1 Lpd_13
  s_sleep 1
  s_sub_u32 s78, s78, 1
  s_cmp_lg_u32 s78, 0
  s_cbranch_scc1 Lpoll_11
Lpd_13:
  v_add_f32 v200, v200, v204
  v_add_f32 v202, v202, v206
  v_cvt_pk_bf16_f32 v200, v200, v202
  ds_write_b32 v220, v200 offset:0
  s_waitcnt lgkmcnt(0)
Lqb_10:
  v_lshrrev_b32 v221, 4, v1
  v_lshlrev_b32 v221, 6, v221
  v_and_b32 v222, 3, v1
  v_lshl_add_u32 v221, v222, 4, v221
  s_waitcnt vmcnt(0)
  s_barrier
  ds_read_b128 v[200:203], v221 offset:8192
  ds_read_b128 v[204:207], v221 offset:8448
  s_waitcnt lgkmcnt(0)
  v_mfma_f32_16x16x32_bf16 v[16:19], v[72:75], v[200:203], 0
  v_mfma_f32_16x16x32_bf16 v[16:19], v[76:79], v[204:207], v[16:19]
  v_mfma_f32_16x16x32_bf16 v[20:23], v[80:83], v[200:203], 0
  v_mfma_f32_16x16x32_bf16 v[20:23], v[84:87], v[204:207], v[20:23]
  v_mfma_f32_16x16x32_bf16 v[24:27], v[88:91], v[200:203], 0
  v_mfma_f32_16x16x32_bf16 v[24:27], v[92:95], v[204:207], v[24:27]
  v_mfma_f32_16x16x32_bf16 v[28:31], v[96:99], v[200:203], 0
  v_mfma_f32_16x16x32_bf16 v[28:31], v[100:103], v[204:207], v[28:31]
  v_mfma_f32_16x16x32_bf16 v[32:35], v[104:107], v[200:203], 0
  v_mfma_f32_16x16x32_bf16 v[32:35], v[108:111], v[204:207], v[32:35]
  v_mfma_f32_16x16x32_bf16 v[36:39], v[112:115], v[200:203], 0
  v_mfma_f32_16x16x32_bf16 v[36:39], v[116:119], v[204:207], v[36:39]
  v_mfma_f32_16x16x32_bf16 v[40:43], v[120:123], v[200:203], 0
  v_mfma_f32_16x16x32_bf16 v[40:43], v[124:127], v[204:207], v[40:43]
  v_mfma_f32_16x16x32_bf16 v[44:47], v[128:131], v[200:203], 0
  v_mfma_f32_16x16x32_bf16 v[44:47], v[132:135], v[204:207], v[44:47]
  v_mov_b32_dpp v208, v16 quad_perm:[0,0,0,0] row_mask:0xf bank_mask:0xf
  v_mov_b32_dpp v209, v20 quad_perm:[0,0,0,0] row_mask:0xf bank_mask:0xf
  v_mov_b32_dpp v210, v24 quad_perm:[0,0,0,0] row_mask:0xf bank_mask:0xf
  v_mov_b32_dpp v211, v28 quad_perm:[0,0,0,0] row_mask:0xf bank_mask:0xf
  v_mov_b32_dpp v212, v32 quad_perm:[0,0,0,0] row_mask:0xf bank_mask:0xf
  v_mov_b32_dpp v213, v36 quad_perm:[0,0,0,0] row_mask:0xf bank_mask:0xf
  v_mov_b32_dpp v214, v40 quad_perm:[0,0,0,0] row_mask:0xf bank_mask:0xf
  s_nop 0
  v_mov_b32_dpp v215, v44 quad_perm:[0,0,0,0] row_mask:0xf bank_mask:0xf
  v_add_f32_dpp v208, v17, v208 quad_perm:[1,1,1,1] row_mask:0xf bank_mask:0xf
  v_add_f32_dpp v209, v21, v209 quad_perm:[1,1,1,1] row_mask:0xf bank_mask:0xf
  v_add_f32_dpp v210, v25, v210 quad_perm:[1,1,1,1] row_mask:0xf bank_mask:0xf
  v_add_f32_dpp v211, v29, v211 quad_perm:[1,1,1,1] row_mask:0xf bank_mask:0xf
  v_add_f32_dpp v212, v33, v212 quad_perm:[1,1,1,1] row_mask:0xf bank_mask:0xf
  v_add_f32_dpp v213, v37, v213 quad_perm:[1,1,1,1] row_mask:0xf bank_mask:0xf
  v_add_f32_dpp v214, v41, v214 quad_perm:[1,1,1,1] row_mask:0xf bank_mask:0xf
  v_add_f32_dpp v215, v45, v215 quad_perm:[1,1,1,1] row_mask:0xf bank_mask:0xf
  v_add_f32_dpp v208, v18, v208 quad_perm:[2,2,2,2] row_mask:0xf bank_mask:0xf
  v_add_f32_dpp v209, v22, v209 quad_perm:[2,2,2,2] row_mask:0xf bank_mask:0xf
  v_add_f32_dpp v210, v26, v210 quad_perm:[2,2,2,2] row_mask:0xf bank_mask:0xf
  v_add_f32_dpp v211, v30, v211 quad_perm:[2,2,2,2] row_mask:0xf bank_mask:0xf
  v_add_f32_dpp v212, v34, v212 quad_perm:[2,2,2,2] row_mask:0xf bank_mask:0xf
  v_add_f32_dpp v213, v38, v213 quad_perm:[2,2,2,2] row_mask:0xf bank_mask:0xf
  v_add_f32_dpp v214, v42, v214 quad_perm:[2,2,2,2] row_mask:0xf bank_mask:0xf
  v_add_f32_dpp v215, v46, v215 quad_perm:[2,2,2,2] row_mask:0xf bank_mask:0xf
  v_add_f32_dpp v208, v19, v208 quad_perm:[3,3,3,3] row_mask:0xf bank_mask:0xf
  v_add_f32_dpp v209, v23, v209 quad_perm:[3,3,3,3] row_mask:0xf bank_mask:0xf
  v_add_f32_dpp v210, v27, v210 quad_perm:[3,3,3,3] row_mask:0xf bank_mask:0xf
  v_add_f32_dpp v211, v31, v211 quad_perm:[3,3,3,3] row_mask:0xf bank_mask:0xf
  v_add_f32_dpp v212, v35, v212 quad_perm:[3,3,3,3] row_mask:0xf bank_mask:0xf
  v_add_f32_dpp v213, v39, v213 quad_perm:[3,3,3,3] row_mask:0xf bank_mask:0xf
  v_add_f32_dpp v214, v43, v214 quad_perm:[3,3,3,3] row_mask:0xf bank_mask:0xf
  v_add_f32_dpp v215, v47, v215 quad_perm:[3,3,3,3] row_mask:0xf bank_mask:0xf
  v_cvt_pk_bf16_f32 v216, v208, v209
  v_cvt_pk_bf16_f32 v217, v210, v211
  v_cvt_pk_bf16_f32 v218, v212, v213
  v_cvt_pk_bf16_f32 v219, v214, v215
  v_min_u32 v216, -2, v216
  v_min_u32 v217, -2, v217
  v_min_u32 v218, -2, v218
  v_min_u32 v219, -2, v219
  s_mov_b32 exec_lo, 0x10001
  s_mov_b32 exec_hi, 0x10001
  ds_write_b128 v251, v[216:219] offset:10496
  s_mov_b64 exec, -1
  s_waitcnt lgkmcnt(0)
  s_barrier
  s_cmp_lg_u32 s3, 3
  s_cbranch_scc1 Lqp_14
  s_mov_b32 exec_lo, 0xffff
  s_mov_b32 exec_hi, 0x0
  ds_read_b128 v[216:219], v6 offset:10496
  s_waitcnt lgkmcnt(0)
  buffer_store_dwordx4 v[216:219], v6, s[44:47], s14 offen sc1
  s_mov_b64 exec, -1
Lqp_14:
  v_lshrrev_b32 v250, 4, v1
  v_lshlrev_b32 v250, 13, v250
  v_and_b32 v222, 15, v1
  v_lshl_add_u32 v250, v222, 4, v250
  s_add_u32 s79, s15, 0
  s_waitcnt vmcnt(7)
  buffer_load_dwordx4 v[136:139], v250, s[72:75], s79 offen offset:0 nt
  s_add_u32 s79, s15, 0
  s_waitcnt vmcnt(7)
  buffer_load_dwordx4 v[140:143], v250, s[72:75], s79 offen offset:256 nt
  s_add_u32 s79, s15, 32768
  s_waitcnt vmcnt(7)
  buffer_load_dwordx4 v[144:147], v250, s[72:75], s79 offen offset:0 nt
  s_add_u32 s79, s15, 32768
  s_waitcnt vmcnt(7)
  buffer_load_dwordx4 v[148:151], v250, s[72:75], s79 offen offset:256 nt
  s_add_u32 s79, s15, 65536
  s_waitcnt vmcnt(7)
  buffer_load_dwordx4 v[152:155], v250, s[72:75], s79 offen offset:0 nt
  s_add_u32 s79, s15, 65536
  s_waitcnt vmcnt(7)
  buffer_load_dwordx4 v[156:159], v250, s[72:75], s79 offen offset:256 nt
  s_add_u32 s79, s15, 98304
  s_waitcnt vmcnt(7)
  buffer_load_dwordx4 v[160:163], v250, s[72:75], s79 offen offset:0 nt
  s_add_u32 s79, s15, 98304
  s_waitcnt vmcnt(7)
  buffer_load_dwordx4 v[164:167], v250, s[72:75], s79 offen offset:256 nt
  s_add_u32 s79, s15, 131072
  s_waitcnt vmcnt(7)
  buffer_load_dwordx4 v[168:171], v250, s[72:75], s79 offen offset:0 nt
  s_add_u32 s79, s15, 131072
  s_waitcnt vmcnt(7)
  buffer_load_dwordx4 v[172:175], v250, s[72:75], s79 offen offset:256 nt
  s_add_u32 s79, s15, 163840
  s_waitcnt vmcnt(7)
  buffer_load_dwordx4 v[176:179], v250, s[72:75], s79 offen offset:0 nt
  s_add_u32 s79, s15, 163840
  s_waitcnt vmcnt(7)
  buffer_load_dwordx4 v[180:183], v250, s[72:75], s79 offen offset:256 nt
  s_add_u32 s79, s15, 196608
  s_waitcnt vmcnt(7)
  buffer_load_dwordx4 v[184:187], v250, s[72:75], s79 offen offset:0 nt
  s_add_u32 s79, s15, 196608
  s_waitcnt vmcnt(7)
  buffer_load_dwordx4 v[188:191], v250, s[72:75], s79 offen offset:256 nt
  s_add_u32 s79, s15, 229376
  s_waitcnt vmcnt(7)
  buffer_load_dwordx4 v[192:195], v250, s[72:75], s79 offen offset:0 nt
  s_add_u32 s79, s15, 229376
  s_waitcnt vmcnt(7)
  buffer_load_dwordx4 v[196:199], v250, s[72:75], s79 offen offset:256 nt
  s_mul_i32 s6, s2, 33024
  s_lshl_b32 s5, s3, 13
  s_add_u32 s6, s6, s5
  s_add_u32 s6, s6, 4194304
  s_add_u32 s7, s6, 4096
  v_and_b32 v226, 15, v1
  v_lshlrev_b32 v226, 1, v226
  s_mov_b32 s10, 0xff
  s_sub_u32 s9, 0, s76
  s_cmp_lg_u32 s3, 0
  s_cbranch_scc1 Lst_15
  s_lshl_b32 s5, s12, 11
  s_add_u32 s5, s5, 196608
  s_mov_b32 s78, 2000
  s_add_u32 s64, s5, 4
  s_add_u32 s65, s5, 596
  s_add_u32 s66, s5, 1188
Lsp_16:
  s_load_dword s68, s[42:43], s64 glc
  s_load_dword s69, s[42:43], s65 glc
  s_load_dword s70, s[42:43], s66 glc
  s_waitcnt lgkmcnt(0)
  s_mov_b32 s83, 0
  s_cmp_eq_u32 s68, s76
  s_addc_u32 s83, s83, 0
  s_cmp_eq_u32 s69, s76
  s_addc_u32 s83, s83, 0
  s_cmp_eq_u32 s70, s76
  s_addc_u32 s83, s83, 0
  s_cmp_ge_u32 s83, 3
  s_cbranch_scc1 Lspd_17
  s_sleep 2
  s_sub_u32 s78, s78, 1
  s_cmp_lg_u32 s78, 0
  s_cbranch_scc1 Lsp_16
Lspd_17:
  s_mov_b32 s78, 100000
Lpoll_18:
  buffer_load_dwordx4 v[200:203], v6, s[44:47], s5 offen offset:0 sc1
  buffer_load_dwordx4 v[204:207], v6, s[44:47], s5 offen offset:1024 sc1
Lpw_19:
  s_waitcnt vmcnt(0)
  v_bitop3_b32 v208, v201, v203, s76 bitop3:0x7e
  v_bitop3_b32 v209, v205, v207, s76 bitop3:0x7e
  v_or3_b32 v208, v208, v209, v209
  v_cmp_ne_u32 vcc, 0, v208
  s_nop 0
  s_cmp_eq_u64 vcc, 0
  s_nop 1
  s_cbranch_scc1 Lpd_20
  s_sleep 2
  s_sub_u32 s78, s78, 1
  s_cmp_lg_u32 s78, 0
  s_cbranch_scc1 Lpoll_18
Lpd_20:
Lst_15:
  s_barrier
  buffer_load_dwordx4 v[72:75], v6, s[44:47], s6 offen offset:0 sc1
  buffer_load_dwordx4 v[76:79], v6, s[44:47], s6 offen offset:1024 sc1
  buffer_load_dwordx4 v[80:83], v6, s[44:47], s6 offen offset:2048 sc1
  buffer_load_dwordx4 v[84:87], v6, s[44:47], s6 offen offset:3072 sc1
  buffer_load_dwordx4 v[88:91], v6, s[44:47], s7 offen offset:0 sc1
  buffer_load_dwordx4 v[92:95], v6, s[44:47], s7 offen offset:1024 sc1
  buffer_load_dwordx4 v[96:99], v6, s[44:47], s7 offen offset:2048 sc1
  buffer_load_dwordx4 v[100:103], v6, s[44:47], s7 offen offset:3072 sc1
  s_cmp_lg_u32 s3, 0
  s_cbranch_scc1 Lwt_29
  v_max_f32 v208, v200, v204
  s_nop 1
  v_max_f32_dpp v208, v208, v208 quad_perm:[1,0,3,2] row_mask:0xf bank_mask:0xf
  s_nop 1
  v_max_f32_dpp v208, v208, v208 quad_perm:[2,3,0,1] row_mask:0xf bank_mask:0xf
  s_nop 1
  v_max_f32_dpp v208, v208, v208 row_half_mirror row_mask:0xf bank_mask:0xf
  s_nop 1
  v_max_f32_dpp v208, v208, v208 row_mirror row_mask:0xf bank_mask:0xf
  v_mov_b32 v210, v208
  s_nop 1
  v_permlane32_swap_b32 v208, v210
  v_max_f32 v208, v208, v210
  v_mov_b32 v210, v208
  s_nop 1
  v_permlane16_swap_b32 v208, v210
  v_max_f32 v208, v208, v210
  v_sub_f32 v212, v200, v208
  v_sub_f32 v213, v204, v208
  v_exp_f32 v212, v212
  v_exp_f32 v213, v213
  v_mul_f32 v209, v212, v202
  v_fmac_f32 v209, v213, v206
  s_nop 1
  v_add_f32_dpp v209, v209, v209 quad_perm:[1,0,3,2] row_mask:0xf bank_mask:0xf
  s_nop 1
  v_add_f32_dpp v209, v209, v209 quad_perm:[2,3,0,1] row_mask:0xf bank_mask:0xf
  s_nop 1
  v_add_f32_dpp v209, v209, v209 row_half_mirror row_mask:0xf bank_mask:0xf
  s_nop 1
  v_add_f32_dpp v209, v209, v209 row_mirror row_mask:0xf bank_mask:0xf
  v_mov_b32 v210, v209
  s_nop 1
  v_permlane32_swap_b32 v209, v210
  v_add_f32 v209, v209, v210
  v_mov_b32 v210, v209
  s_nop 1
  v_permlane16_swap_b32 v209, v210
  v_add_f32 v209, v209, v210
  v_rcp_f32 v209, v209
  v_and_b32 v210, 3, v1
  v_lshlrev_b32 v210, 7, v210
  v_lshrrev_b32 v211, 5, v1
  v_lshl_add_u32 v210, v211, 5, v210
  v_bfe_u32 v211, v1, 2, 3
  v_lshl_add_u32 v210, v211, 2, v210
  v_mul_f32 v212, v212, v209
  v_cvt_pk_bf16_f32 v214, v212, v212
  v_and_b32 v216, 0xffff0000, v214
  v_sub_f32 v216, v212, v216
  v_cvt_pk_bf16_f32 v216, v216, v216
  ds_write_b32 v210, v214 offset:12288
  ds_write_b32 v210, v216 offset:12800
  v_mul_f32 v213, v213, v209
  v_cvt_pk_bf16_f32 v215, v213, v213
  v_and_b32 v217, 0xffff0000, v215
  v_sub_f32 v217, v213, v217
  v_cvt_pk_bf16_f32 v217, v217, v217
  ds_write_b32 v210, v215 offset:12352
  ds_write_b32 v210, v217 offset:12864
  s_waitcnt lgkmcnt(0)
Lwt_29:
  v_bfe_u32 v220, v1, 3, 1
  v_lshlrev_b32 v220, 9, v220
  v_lshrrev_b32 v221, 4, v1
  v_lshl_add_u32 v220, v221, 7, v220
  s_lshl_b32 s5, s3, 5
  v_add_u32 v220, s5, v220
  v_and_b32 v222, 1, v1
  v_lshlrev_b32 v222, 8, v222
  v_bfe_u32 v223, v1, 1, 2
  v_lshl_add_u32 v222, v223, 4, v222
  v_lshl_add_u32 v222, v221, 2, v222
  s_lshl_b32 s5, s3, 6
  v_add_u32 v222, s5, v222
  s_barrier
  ds_read_b128 v[200:203], v220 offset:12288
  ds_read_b128 v[204:207], v220 offset:12304
  s_waitcnt lgkmcnt(0)
  v_and_b32 v16, v200, v2
  v_and_b32 v17, v200, v3
  v_and_b32 v18, v200, v4
  v_and_b32 v19, v200, v5
  v_and_b32 v20, v201, v2
  v_and_b32 v21, v201, v3
  v_and_b32 v22, v201, v4
  v_and_b32 v23, v201, v5
  v_and_b32 v24, v202, v2
  v_and_b32 v25, v202, v3
  v_and_b32 v26, v202, v4
  v_and_b32 v27, v202, v5
  v_and_b32 v28, v203, v2
  v_and_b32 v29, v203, v3
  v_and_b32 v30, v203, v4
  v_and_b32 v31, v203, v5
  v_and_b32 v32, v204, v2
  v_and_b32 v33, v204, v3
  v_and_b32 v34, v204, v4
  v_and_b32 v35, v204, v5
  v_and_b32 v36, v205, v2
  v_and_b32 v37, v205, v3
  v_and_b32 v38, v205, v4
  v_and_b32 v39, v205, v5
  v_and_b32 v40, v206, v2
  v_and_b32 v41, v206, v3
  v_and_b32 v42, v206, v4
  v_and_b32 v43, v206, v5
  v_and_b32 v44, v207, v2
  v_and_b32 v45, v207, v3
  v_and_b32 v46, v207, v4
  v_and_b32 v47, v207, v5
  s_mov_b32 s78, 100000
  s_branch Lckw_31
Lck_30:
  s_bitcmp0_b32 s10, 0
  s_cbranch_scc1 Lhg_33
  buffer_load_dwordx4 v[72:75], v6, s[44:47], s6 offen offset:0 sc1
Lhg_33:
  s_bitcmp0_b32 s10, 1
  s_cbranch_scc1 Lhg_34
  buffer_load_dwordx4 v[76:79], v6, s[44:47], s6 offen offset:1024 sc1
Lhg_34:
  s_bitcmp0_b32 s10, 2
  s_cbranch_scc1 Lhg_35
  buffer_load_dwordx4 v[80:83], v6, s[44:47], s6 offen offset:2048 sc1
Lhg_35:
  s_bitcmp0_b32 s10, 3
  s_cbranch_scc1 Lhg_36
  buffer_load_dwordx4 v[84:87], v6, s[44:47], s6 offen offset:3072 sc1
Lhg_36:
  s_bitcmp0_b32 s10, 4
  s_cbranch_scc1 Lhg_37
  buffer_load_dwordx4 v[88:91], v6, s[44:47], s7 offen offset:0 sc1
Lhg_37:
  s_bitcmp0_b32 s10, 5
  s_cbranch_scc1 Lhg_38
  buffer_load_dwordx4 v[92:95], v6, s[44:47], s7 offen offset:1024 sc1
Lhg_38:
  s_bitcmp0_b32 s10, 6
  s_cbranch_scc1 Lhg_39
  buffer_load_dwordx4 v[96:99], v6, s[44:47], s7 offen offset:2048 sc1
Lhg_39:
  s_bitcmp0_b32 s10, 7
  s_cbranch_scc1 Lhg_40
  buffer_load_dwordx4 v[100:103], v6, s[44:47], s7 offen offset:3072 sc1
Lhg_40:
Lckw_31:
  s_waitcnt vmcnt(0)
  v_and_b32 v56, 3, v72
  v_add3_u32 v48, v72, v73, v74
  v_and_or_b32 v72, v72, -4, 2
  v_lshl_add_u32 v56, v56, v226, v56
  v_add_u32 v48, v48, v75
  v_mfma_f32_16x16x32_bf16 v[208:211], v[16:19], v[72:75], 0
  v_sub_u32 v48, v48, v56
  v_and_b32 v57, 3, v76
  v_add3_u32 v49, v76, v77, v78
  v_and_or_b32 v76, v76, -4, 2
  v_lshl_add_u32 v57, v57, v226, v57
  v_add_u32 v49, v49, v79
  v_mfma_f32_16x16x32_bf16 v[208:211], v[20:23], v[76:79], v[208:211]
  v_sub_u32 v49, v49, v57
  v_and_b32 v58, 3, v80
  v_add3_u32 v50, v80, v81, v82
  v_and_or_b32 v80, v80, -4, 2
  v_lshl_add_u32 v58, v58, v226, v58
  v_add_u32 v50, v50, v83
  v_mfma_f32_16x16x32_bf16 v[208:211], v[24:27], v[80:83], v[208:211]
  v_sub_u32 v50, v50, v58
  v_and_b32 v59, 3, v84
  v_add3_u32 v51, v84, v85, v86
  v_and_or_b32 v84, v84, -4, 2
  v_lshl_add_u32 v59, v59, v226, v59
  v_add_u32 v51, v51, v87
  v_mfma_f32_16x16x32_bf16 v[208:211], v[28:31], v[84:87], v[208:211]
  v_sub_u32 v51, v51, v59
  v_and_b32 v60, 3, v88
  v_add3_u32 v52, v88, v89, v90
  v_and_or_b32 v88, v88, -4, 2
  v_lshl_add_u32 v60, v60, v226, v60
  v_add_u32 v52, v52, v91
  v_mfma_f32_16x16x32_bf16 v[208:211], v[32:35], v[88:91], v[208:211]
  v_sub_u32 v52, v52, v60
  v_and_b32 v61, 3, v92
  v_add3_u32 v53, v92, v93, v94
  v_and_or_b32 v92, v92, -4, 2
  v_lshl_add_u32 v61, v61, v226, v61
  v_add_u32 v53, v53, v95
  v_mfma_f32_16x16x32_bf16 v[208:211], v[36:39], v[92:95], v[208:211]
  v_sub_u32 v53, v53, v61
  v_and_b32 v62, 3, v96
  v_add3_u32 v54, v96, v97, v98
  v_and_or_b32 v96, v96, -4, 2
  v_lshl_add_u32 v62, v62, v226, v62
  v_add_u32 v54, v54, v99
  v_mfma_f32_16x16x32_bf16 v[208:211], v[40:43], v[96:99], v[208:211]
  v_sub_u32 v54, v54, v62
  v_and_b32 v63, 3, v100
  v_add3_u32 v55, v100, v101, v102
  v_and_or_b32 v100, v100, -4, 2
  v_lshl_add_u32 v63, v63, v226, v63
  v_add_u32 v55, v55, v103
  v_mfma_f32_16x16x32_bf16 v[208:211], v[44:47], v[100:103], v[208:211]
  v_sub_u32 v55, v55, v63
  v_add_u32_dpp v48, v48, v48 quad_perm:[1,0,3,2] row_mask:0xf bank_mask:0xf
  v_add_u32_dpp v49, v49, v49 quad_perm:[1,0,3,2] row_mask:0xf bank_mask:0xf
  v_add_u32_dpp v50, v50, v50 quad_perm:[1,0,3,2] row_mask:0xf bank_mask:0xf
  v_add_u32_dpp v51, v51, v51 quad_perm:[1,0,3,2] row_mask:0xf bank_mask:0xf
  v_add_u32_dpp v52, v52, v52 quad_perm:[1,0,3,2] row_mask:0xf bank_mask:0xf
  v_add_u32_dpp v53, v53, v53 quad_perm:[1,0,3,2] row_mask:0xf bank_mask:0xf
  v_add_u32_dpp v54, v54, v54 quad_perm:[1,0,3,2] row_mask:0xf bank_mask:0xf
  v_add_u32_dpp v55, v55, v55 quad_perm:[1,0,3,2] row_mask:0xf bank_mask:0xf
  v_add_u32_dpp v48, v48, v48 quad_perm:[2,3,0,1] row_mask:0xf bank_mask:0xf
  v_add_u32_dpp v49, v49, v49 quad_perm:[2,3,0,1] row_mask:0xf bank_mask:0xf
  v_add_u32_dpp v50, v50, v50 quad_perm:[2,3,0,1] row_mask:0xf bank_mask:0xf
  v_add_u32_dpp v51, v51, v51 quad_perm:[2,3,0,1] row_mask:0xf bank_mask:0xf
  v_add_u32_dpp v52, v52, v52 quad_perm:[2,3,0,1] row_mask:0xf bank_mask:0xf
  v_add_u32_dpp v53, v53, v53 quad_perm:[2,3,0,1] row_mask:0xf bank_mask:0xf
  v_add_u32_dpp v54, v54, v54 quad_perm:[2,3,0,1] row_mask:0xf bank_mask:0xf
  v_add_u32_dpp v55, v55, v55 quad_perm:[2,3,0,1] row_mask:0xf bank_mask:0xf
  v_add_u32_dpp v48, v48, v48 row_half_mirror row_mask:0xf bank_mask:0xf
  v_add_u32_dpp v49, v49, v49 row_half_mirror row_mask:0xf bank_mask:0xf
  v_add_u32_dpp v50, v50, v50 row_half_mirror row_mask:0xf bank_mask:0xf
  v_add_u32_dpp v51, v51, v51 row_half_mirror row_mask:0xf bank_mask:0xf
  v_add_u32_dpp v52, v52, v52 row_half_mirror row_mask:0xf bank_mask:0xf
  v_add_u32_dpp v53, v53, v53 row_half_mirror row_mask:0xf bank_mask:0xf
  v_add_u32_dpp v54, v54, v54 row_half_mirror row_mask:0xf bank_mask:0xf
  v_add_u32_dpp v55, v55, v55 row_half_mirror row_mask:0xf bank_mask:0xf
  v_add_u32_dpp v48, v48, v48 row_mirror row_mask:0xf bank_mask:0xf
  v_add_u32_dpp v49, v49, v49 row_mirror row_mask:0xf bank_mask:0xf
  v_add_u32_dpp v50, v50, v50 row_mirror row_mask:0xf bank_mask:0xf
  v_add_u32_dpp v51, v51, v51 row_mirror row_mask:0xf bank_mask:0xf
  v_add_u32_dpp v52, v52, v52 row_mirror row_mask:0xf bank_mask:0xf
  v_add_u32_dpp v53, v53, v53 row_mirror row_mask:0xf bank_mask:0xf
  v_add_u32_dpp v54, v54, v54 row_mirror row_mask:0xf bank_mask:0xf
  v_add_u32_dpp v55, v55, v55 row_mirror row_mask:0xf bank_mask:0xf
  v_cmp_ne_u32 s[64:65], s9, v48
  v_cmp_ne_u32 s[66:67], s9, v49
  v_cmp_ne_u32 s[68:69], s9, v50
  v_cmp_ne_u32 s[70:71], s9, v51
  s_mov_b32 s11, 0
  s_cmp_lg_u64 s[64:65], 0
  s_cselect_b32 s5, 1, 0
  s_or_b32 s11, s11, s5
  s_cmp_lg_u64 s[66:67], 0
  s_cselect_b32 s5, 2, 0
  s_or_b32 s11, s11, s5
  s_cmp_lg_u64 s[68:69], 0
  s_cselect_b32 s5, 4, 0
  s_or_b32 s11, s11, s5
  s_cmp_lg_u64 s[70:71], 0
  s_cselect_b32 s5, 8, 0
  s_or_b32 s11, s11, s5
  v_cmp_ne_u32 s[64:65], s9, v52
  v_cmp_ne_u32 s[66:67], s9, v53
  v_cmp_ne_u32 s[68:69], s9, v54
  v_cmp_ne_u32 s[70:71], s9, v55
  s_cmp_lg_u64 s[64:65], 0
  s_cselect_b32 s5, 16, 0
  s_or_b32 s11, s11, s5
  s_cmp_lg_u64 s[66:67], 0
  s_cselect_b32 s5, 32, 0
  s_or_b32 s11, s11, s5
  s_cmp_lg_u64 s[68:69], 0
  s_cselect_b32 s5, 64, 0
  s_or_b32 s11, s11, s5
  s_cmp_lg_u64 s[70:71], 0
  s_cselect_b32 s5, 128, 0
  s_or_b32 s11, s11, s5
  s_and_b32 s10, s10, s11
  s_cbranch_scc0 Lckd_32
  s_sleep 1
  s_sub_u32 s78, s78, 1
  s_cmp_lg_u32 s78, 0
  s_cbranch_scc1 Lck_30
Lckd_32:
  ds_write_b128 v244, v[208:211]
  s_waitcnt lgkmcnt(0)
  s_barrier
  ds_read_b32 v212, v222 offset:0
  ds_read_b32 v213, v222 offset:512
  ds_read_b32 v214, v222 offset:1024
  ds_read_b32 v215, v222 offset:1536
  ds_read_b32 v216, v222 offset:2048
  ds_read_b32 v217, v222 offset:2560
  ds_read_b32 v218, v222 offset:3072
  ds_read_b32 v219, v222 offset:3584
  v_bfe_u32 v227, v0, 6, 1
  v_lshlrev_b32 v227, 10, v227
  v_bfe_u32 v225, v0, 1, 1
  v_lshl_add_u32 v227, v225, 8, v227
  v_bfe_u32 v225, v0, 2, 4
  v_lshl_add_u32 v227, v225, 4, v227
  v_and_b32 v225, 1, v0
  v_lshl_add_u32 v227, v225, 3, v227
  v_lshlrev_b32 v224, 4, v0
  s_lshl_b32 s5, s3, 11
  v_add_u32 v226, s5, v6
  s_lshl_b32 s5, s2, 11
  s_add_u32 s5, s5, 262144
  s_waitcnt lgkmcnt(0)
  v_pk_add_f32 v[212:213], v[212:213], v[216:217]
  v_pk_add_f32 v[214:215], v[214:215], v[218:219]
  v_pk_add_f32 v[212:213], v[212:213], v[214:215]
  v_add_f32 v212, v212, v213
  v_cvt_pk_bf16_f32 v212, v212, v212
  s_nop 1
  v_and_b32_dpp v200, v212, v2 row_newbcast:0 row_mask:0xf bank_mask:0xf
  v_and_b32_dpp v201, v212, v3 row_newbcast:0 row_mask:0xf bank_mask:0xf
  v_and_b32_dpp v202, v212, v4 row_newbcast:0 row_mask:0xf bank_mask:0xf
  v_and_b32_dpp v203, v212, v5 row_newbcast:0 row_mask:0xf bank_mask:0xf
  s_nop 1
  v_mfma_f32_16x16x32_bf16 v[228:231], v[200:203], v[136:139], 0
  v_mfma_f32_16x16x32_bf16 v[232:235], v[200:203], v[140:143], 0
  v_and_b32_dpp v204, v212, v2 row_newbcast:1 row_mask:0xf bank_mask:0xf
  v_and_b32_dpp v205, v212, v3 row_newbcast:1 row_mask:0xf bank_mask:0xf
  v_and_b32_dpp v206, v212, v4 row_newbcast:1 row_mask:0xf bank_mask:0xf
  v_and_b32_dpp v207, v212, v5 row_newbcast:1 row_mask:0xf bank_mask:0xf
  s_nop 1
  v_mfma_f32_16x16x32_bf16 v[228:231], v[204:207], v[144:147], v[228:231]
  v_mfma_f32_16x16x32_bf16 v[232:235], v[204:207], v[148:151], v[232:235]
  v_and_b32_dpp v200, v212, v2 row_newbcast:2 row_mask:0xf bank_mask:0xf
  v_and_b32_dpp v201, v212, v3 row_newbcast:2 row_mask:0xf bank_mask:0xf
  v_and_b32_dpp v202, v212, v4 row_newbcast:2 row_mask:0xf bank_mask:0xf
  v_and_b32_dpp v203, v212, v5 row_newbcast:2 row_mask:0xf bank_mask:0xf
  s_nop 1
  v_mfma_f32_16x16x32_bf16 v[228:231], v[200:203], v[152:155], v[228:231]
  v_mfma_f32_16x16x32_bf16 v[232:235], v[200:203], v[156:159], v[232:235]
  v_and_b32_dpp v204, v212, v2 row_newbcast:3 row_mask:0xf bank_mask:0xf
  v_and_b32_dpp v205, v212, v3 row_newbcast:3 row_mask:0xf bank_mask:0xf
  v_and_b32_dpp v206, v212, v4 row_newbcast:3 row_mask:0xf bank_mask:0xf
  v_and_b32_dpp v207, v212, v5 row_newbcast:3 row_mask:0xf bank_mask:0xf
  s_nop 1
  v_mfma_f32_16x16x32_bf16 v[228:231], v[204:207], v[160:163], v[228:231]
  v_mfma_f32_16x16x32_bf16 v[232:235], v[204:207], v[164:167], v[232:235]
  v_and_b32_dpp v200, v212, v2 row_newbcast:4 row_mask:0xf bank_mask:0xf
  v_and_b32_dpp v201, v212, v3 row_newbcast:4 row_mask:0xf bank_mask:0xf
  v_and_b32_dpp v202, v212, v4 row_newbcast:4 row_mask:0xf bank_mask:0xf
  v_and_b32_dpp v203, v212, v5 row_newbcast:4 row_mask:0xf bank_mask:0xf
  s_nop 1
  v_mfma_f32_16x16x32_bf16 v[228:231], v[200:203], v[168:171], v[228:231]
  v_mfma_f32_16x16x32_bf16 v[232:235], v[200:203], v[172:175], v[232:235]
  v_and_b32_dpp v204, v212, v2 row_newbcast:5 row_mask:0xf bank_mask:0xf
  v_and_b32_dpp v205, v212, v3 row_newbcast:5 row_mask:0xf bank_mask:0xf
  v_and_b32_dpp v206, v212, v4 row_newbcast:5 row_mask:0xf bank_mask:0xf
  v_and_b32_dpp v207, v212, v5 row_newbcast:5 row_mask:0xf bank_mask:0xf
  s_nop 1
  v_mfma_f32_16x16x32_bf16 v[228:231], v[204:207], v[176:179], v[228:231]
  v_mfma_f32_16x16x32_bf16 v[232:235], v[204:207], v[180:183], v[232:235]
  v_and_b32_dpp v200, v212, v2 row_newbcast:6 row_mask:0xf bank_mask:0xf
  v_and_b32_dpp v201, v212, v3 row_newbcast:6 row_mask:0xf bank_mask:0xf
  v_and_b32_dpp v202, v212, v4 row_newbcast:6 row_mask:0xf bank_mask:0xf
  v_and_b32_dpp v203, v212, v5 row_newbcast:6 row_mask:0xf bank_mask:0xf
  s_nop 1
  v_mfma_f32_16x16x32_bf16 v[228:231], v[200:203], v[184:187], v[228:231]
  v_mfma_f32_16x16x32_bf16 v[232:235], v[200:203], v[188:191], v[232:235]
  v_and_b32_dpp v204, v212, v2 row_newbcast:7 row_mask:0xf bank_mask:0xf
  v_and_b32_dpp v205, v212, v3 row_newbcast:7 row_mask:0xf bank_mask:0xf
  v_and_b32_dpp v206, v212, v4 row_newbcast:7 row_mask:0xf bank_mask:0xf
  v_and_b32_dpp v207, v212, v5 row_newbcast:7 row_mask:0xf bank_mask:0xf
  s_nop 1
  v_mfma_f32_16x16x32_bf16 v[228:231], v[204:207], v[192:195], v[228:231]
  v_mfma_f32_16x16x32_bf16 v[232:235], v[204:207], v[196:199], v[232:235]
  s_nop 6
  ds_write_b128 v226, v[228:231] offset:16384
  ds_write_b128 v226, v[232:235] offset:17408
  s_waitcnt lgkmcnt(0)
  s_barrier
  s_cmp_ge_u32 s3, 2
  s_cbranch_scc1 L_ya5
  ds_read_b64 v[200:201], v227 offset:16384
  ds_read_b64 v[202:203], v227 offset:18432
  ds_read_b64 v[204:205], v227 offset:20480
  ds_read_b64 v[206:207], v227 offset:22528
  s_waitcnt lgkmcnt(0)
  v_pk_add_f32 v[200:201], v[200:201], v[204:205]
  v_pk_add_f32 v[202:203], v[202:203], v[206:207]
  v_pk_add_f32 v[200:201], v[200:201], v[202:203]
  v_mov_b32 v202, v201
  v_mov_b32 v201, s76
  v_mov_b32 v203, s76
  buffer_store_dwordx4 v[200:203], v224, s[44:47], s5 offen sc1
L_ya5:
  s_endpgm
L_X:
  s_sub_u32 s11, s2, 128
  s_lshl_b32 s8, s11, 17
  s_lshl_b32 s6, s3, 13
  s_add_u32 s8, s8, s6
  s_mul_i32 s9, s3, 8320
  s_waitcnt lgkmcnt(0)
  s_or_b32 s77, s4, 1
  s_mov_b32 s52, s28
  s_mov_b32 s53, s29
  s_mov_b32 s54, 16777216
  s_mov_b32 s55, 0x20000
  s_add_u32 m0, s9, 0
  s_add_u32 s79, s8, 0
  s_waitcnt vmcnt(3)
  buffer_load_dwordx4 v6, s[52:55], s79 offen offset:0 nt lds
  s_waitcnt vmcnt(3)
  buffer_load_dwordx4 v6, s[52:55], s79 offen offset:1024 nt lds
  s_add_u32 m0, s9, 2080
  s_add_u32 s79, s8, 2048
  s_waitcnt vmcnt(3)
  buffer_load_dwordx4 v6, s[52:55], s79 offen offset:0 nt lds
  s_waitcnt vmcnt(3)
  buffer_load_dwordx4 v6, s[52:55], s79 offen offset:1024 nt lds
  s_add_u32 m0, s9, 4160
  s_add_u32 s79, s8, 4096
  s_waitcnt vmcnt(3)
  buffer_load_dwordx4 v6, s[52:55], s79 offen offset:0 nt lds
  s_waitcnt vmcnt(3)
  buffer_load_dwordx4 v6, s[52:55], s79 offen offset:1024 nt lds
  s_add_u32 m0, s9, 6240
  s_add_u32 s79, s8, 6144
  s_waitcnt vmcnt(3)
  buffer_load_dwordx4 v6, s[52:55], s79 offen offset:0 nt lds
  s_waitcnt vmcnt(3)
  buffer_load_dwordx4 v6, s[52:55], s79 offen offset:1024 nt lds
  s_mov_b32 s44, s42
  s_mov_b32 s45, s43
  s_mov_b32 s46, 268435456
  s_mov_b32 s47, 0x20000
  s_mov_b32 s48, s40
  s_mov_b32 s49, s41
  s_mov_b32 s50, 256
  s_mov_b32 s51, 0x20000
  s_mov_b32 s56, s36
  s_mov_b32 s57, s37
  s_mov_b32 s58, 3670016
  s_mov_b32 s59, 0x20000
  v_and_b32 v13, 1, v1
  v_lshlrev_b32 v13, 4, v13
  v_mov_b32 v14, 0xffff
  v_lshlrev_b32 v13, v13, v14
  v_bfe_u32 v14, v1, 1, 2
  v_cmp_eq_u32 vcc, 0, v14
  s_nop 1
  v_cndmask_b32 v2, 0, v13, vcc
  v_cmp_eq_u32 vcc, 1, v14
  s_nop 1
  v_cndmask_b32 v3, 0, v13, vcc
  v_cmp_eq_u32 vcc, 2, v14
  s_nop 1
  v_cndmask_b32 v4, 0, v13, vcc
  v_cmp_eq_u32 vcc, 3, v14
  s_nop 1
  v_cndmask_b32 v5, 0, v13, vcc
  v_lshrrev_b32 v13, 2, v1
  v_mul_u32_u24 v8, 2080, v13
  v_and_b32 v13, 3, v1
  v_lshl_add_u32 v8, v13, 3, v8
  s_lshl_b32 s5, s3, 9
  v_add_u32 v8, s5, v8
  v_and_b32 v13, 15, v1
  v_mul_u32_u24 v9, 2080, v13
  v_lshrrev_b32 v14, 4, v1
  v_lshl_add_u32 v9, v14, 4, v9
  v_add_u32 v9, s5, v9
  v_add_u32 v10, 66560, v6
  v_mov_b32 v11, 0
  v_lshrrev_b32 v15, 5, v1
  v_lshlrev_b32 v15, 3, v15
  v_bfe_u32 v7, v1, 4, 1
  v_add_u32 v15, v15, v7
  v_mul_u32_u24 v15, 33024, v15
  v_and_b32 v7, 15, v1
  v_lshl_add_u32 v15, v7, 4, v15
  s_mul_i32 s10, s3, 66048
  s_lshl_b32 s5, s11, 8
  s_add_u32 s10, s10, s5
  s_add_u32 s10, s10, 4194304
  s_add_u32 m0, s9, 33280
  s_add_u32 s79, s8, 32768
  s_waitcnt vmcnt(7)
  buffer_load_dwordx4 v6, s[52:55], s79 offen offset:0 nt lds
  s_waitcnt vmcnt(7)
  buffer_load_dwordx4 v6, s[52:55], s79 offen offset:1024 nt lds
  s_add_u32 m0, s9, 35360
  s_add_u32 s79, s8, 34816
  s_waitcnt vmcnt(7)
  buffer_load_dwordx4 v6, s[52:55], s79 offen offset:0 nt lds
  s_waitcnt vmcnt(7)
  buffer_load_dwordx4 v6, s[52:55], s79 offen offset:1024 nt lds
  s_add_u32 m0, s9, 37440
  s_add_u32 s79, s8, 36864
  s_waitcnt vmcnt(7)
  buffer_load_dwordx4 v6, s[52:55], s79 offen offset:0 nt lds
  s_waitcnt vmcnt(7)
  buffer_load_dwordx4 v6, s[52:55], s79 offen offset:1024 nt lds
  s_add_u32 m0, s9, 39520
  s_add_u32 s79, s8, 38912
  s_waitcnt vmcnt(7)
  buffer_load_dwordx4 v6, s[52:55], s79 offen offset:0 nt lds
  s_waitcnt vmcnt(7)
  buffer_load_dwordx4 v6, s[52:55], s79 offen offset:1024 nt lds
  s_lshl_b32 s6, s3, 9
  s_add_u32 s6, s6, 131072
  s_add_u32 s7, s6, 17408
  s_mov_b32 s12, 184320
  s_mov_b32 s13, 0xff
  v_lshrrev_b32 v14, 3, v1
  v_mul_u32_u24 v14, 2176, v14
  v_and_b32 v7, 7, v1
  v_lshl_add_u32 v14, v7, 4, v14
  v_lshlrev_b32 v7, 5, v7
  v_bfe_u32 v13, v1, 3, 1
  v_lshl_add_u32 v7, v13, 4, v7
  v_lshrrev_b32 v13, 4, v1
  v_lshl_add_u32 v7, v13, 2, v7
  v_lshlrev_b32 v13, 3, v1
  s_waitcnt vmcnt(8)
  s_barrier
  ds_read_b128 v[16:19], v9 offset:0
  ds_read_b128 v[20:23], v9 offset:64
  ds_read_b128 v[24:27], v9 offset:128
  ds_read_b128 v[28:31], v9 offset:192
  ds_read_b128 v[32:35], v9 offset:256
  ds_read_b128 v[36:39], v9 offset:320
  ds_read_b128 v[40:43], v9 offset:384
  ds_read_b128 v[44:47], v9 offset:448
  ds_read_b64_tr_b16 v[144:145], v8 offset:0
  ds_read_b64_tr_b16 v[148:149], v8 offset:32
  ds_read_b64_tr_b16 v[152:153], v8 offset:64
  ds_read_b64_tr_b16 v[156:157], v8 offset:96
  ds_read_b64_tr_b16 v[160:161], v8 offset:128
  ds_read_b64_tr_b16 v[164:165], v8 offset:160
  ds_read_b64_tr_b16 v[168:169], v8 offset:192
  ds_read_b64_tr_b16 v[172:173], v8 offset:224
  ds_read_b64_tr_b16 v[176:177], v8 offset:256
  ds_read_b64_tr_b16 v[180:181], v8 offset:288
  ds_read_b64_tr_b16 v[184:185], v8 offset:320
  ds_read_b64_tr_b16 v[188:189], v8 offset:352
  ds_read_b64_tr_b16 v[192:193], v8 offset:384
  ds_read_b64_tr_b16 v[196:197], v8 offset:416
  ds_read_b64_tr_b16 v[200:201], v8 offset:448
  ds_read_b64_tr_b16 v[204:205], v8 offset:480
  s_waitcnt lgkmcnt(0)
  s_barrier
  s_add_u32 m0, s9, 0
  s_add_u32 s79, s8, 65536
  s_waitcnt vmcnt(7)
  buffer_load_dwordx4 v6, s[52:55], s79 offen offset:0 nt lds
  s_waitcnt vmcnt(7)
  buffer_load_dwordx4 v6, s[52:55], s79 offen offset:1024 nt lds
  s_add_u32 m0, s9, 2080
  s_add_u32 s79, s8, 67584
  s_waitcnt vmcnt(7)
  buffer_load_dwordx4 v6, s[52:55], s79 offen offset:0 nt lds
  s_waitcnt vmcnt(7)
  buffer_load_dwordx4 v6, s[52:55], s79 offen offset:1024 nt lds
  s_add_u32 m0, s9, 4160
  s_add_u32 s79, s8, 69632
  s_waitcnt vmcnt(7)
  buffer_load_dwordx4 v6, s[52:55], s79 offen offset:0 nt lds
  s_waitcnt vmcnt(7)
  buffer_load_dwordx4 v6, s[52:55], s79 offen offset:1024 nt lds
  s_add_u32 m0, s9, 6240
  s_add_u32 s79, s8, 71680
  s_waitcnt vmcnt(7)
  buffer_load_dwordx4 v6, s[52:55], s79 offen offset:0 nt lds
  s_waitcnt vmcnt(7)
  buffer_load_dwordx4 v6, s[52:55], s79 offen offset:1024 nt lds
  s_waitcnt vmcnt(8)
  s_barrier
  ds_read_b128 v[48:51], v9 offset:33280
  ds_read_b128 v[52:55], v9 offset:33344
  ds_read_b128 v[56:59], v9 offset:33408
  ds_read_b128 v[60:63], v9 offset:33472
  ds_read_b128 v[64:67], v9 offset:33536
  ds_read_b128 v[68:71], v9 offset:33600
  ds_read_b128 v[72:75], v9 offset:33664
  ds_read_b128 v[76:79], v9 offset:33728
  ds_read_b64_tr_b16 v[146:147], v8 offset:33280
  ds_read_b64_tr_b16 v[150:151], v8 offset:33312
  ds_read_b64_tr_b16 v[154:155], v8 offset:33344
  ds_read_b64_tr_b16 v[158:159], v8 offset:33376
  ds_read_b64_tr_b16 v[162:163], v8 offset:33408
  ds_read_b64_tr_b16 v[166:167], v8 offset:33440
  ds_read_b64_tr_b16 v[170:171], v8 offset:33472
  ds_read_b64_tr_b16 v[174:175], v8 offset:33504
  ds_read_b64_tr_b16 v[178:179], v8 offset:33536
  ds_read_b64_tr_b16 v[182:183], v8 offset:33568
  ds_read_b64_tr_b16 v[186:187], v8 offset:33600
  ds_read_b64_tr_b16 v[190:191], v8 offset:33632
  ds_read_b64_tr_b16 v[194:195], v8 offset:33664
  ds_read_b64_tr_b16 v[198:199], v8 offset:33696
  ds_read_b64_tr_b16 v[202:203], v8 offset:33728
  ds_read_b64_tr_b16 v[206:207], v8 offset:33760
  s_waitcnt lgkmcnt(0)
  s_barrier
  s_cmp_lg_u32 s3, 0
  s_cbranch_scc1 Lcli_41
  buffer_load_dwordx2 v[240:241], v13, s[44:47], s12 offen sc1
  buffer_load_dword v12, v11, s[48:51], 0 offen sc1
Lcli_41:
  s_add_u32 m0, s9, 33280
  s_add_u32 s79, s8, 98304
  s_waitcnt vmcnt(7)
  buffer_load_dwordx4 v6, s[52:55], s79 offen offset:0 nt lds
  s_waitcnt vmcnt(7)
  buffer_load_dwordx4 v6, s[52:55], s79 offen offset:1024 nt lds
  s_add_u32 m0, s9, 35360
  s_add_u32 s79, s8, 100352
  s_waitcnt vmcnt(7)
  buffer_load_dwordx4 v6, s[52:55], s79 offen offset:0 nt lds
  s_waitcnt vmcnt(7)
  buffer_load_dwordx4 v6, s[52:55], s79 offen offset:1024 nt lds
  s_add_u32 m0, s9, 37440
  s_add_u32 s79, s8, 102400
  s_waitcnt vmcnt(7)
  buffer_load_dwordx4 v6, s[52:55], s79 offen offset:0 nt lds
  s_waitcnt vmcnt(7)
  buffer_load_dwordx4 v6, s[52:55], s79 offen offset:1024 nt lds
  s_add_u32 m0, s9, 39520
  s_add_u32 s79, s8, 104448
  s_waitcnt vmcnt(7)
  buffer_load_dwordx4 v6, s[52:55], s79 offen offset:0 nt lds
  s_waitcnt vmcnt(7)
  buffer_load_dwordx4 v6, s[52:55], s79 offen offset:1024 nt lds
  s_waitcnt vmcnt(8)
  s_cmp_lg_u32 s3, 0
  s_cbranch_scc1 Lclr_42
  s_mov_b64 s[80:81], exec
  v_min3_u32 v242, v12, v240, v241
  v_max3_u32 v243, v12, v240, v241
  v_cmp_eq_u32 vcc, v242, v243
  s_nop 0
  s_and_b64 s[80:81], s[80:81], vcc
  v_cmp_ne_u32 vcc, 0, v242
  s_nop 0
  s_and_b64 s[80:81], s[80:81], vcc
  s_cmp_eq_u64 s[80:81], exec
  s_nop 0
  s_cbranch_scc1 Lclk_43
  s_mov_b32 s78, 100000
Lpoll_44:
  buffer_load_dwordx2 v[240:241], v13, s[44:47], s12 offen sc1
  buffer_load_dword v12, v11, s[48:51], 0 offen sc1
Lpw_45:
  s_waitcnt vmcnt(0)
  s_mov_b64 s[80:81], exec
  v_min3_u32 v242, v12, v240, v241
  v_max3_u32 v243, v12, v240, v241
  v_cmp_eq_u32 vcc, v242, v243
  s_nop 0
  s_and_b64 s[80:81], s[80:81], vcc
  v_cmp_ne_u32 vcc, 0, v242
  s_nop 0
  s_and_b64 s[80:81], s[80:81], vcc
  s_cmp_eq_u64 s[80:81], exec
  s_nop 0
  s_cbranch_scc1 Lpd_46
  s_sleep 4
  s_sub_u32 s78, s78, 1
  s_cmp_lg_u32 s78, 0
  s_cbranch_scc1 Lpoll_44
Lpd_46:
Lclk_43:
  ds_write_b32 v10, v12 offset:12288
  s_waitcnt lgkmcnt(0)
Lclr_42:
  s_barrier
  ds_read_b128 v[80:83], v9 offset:0
  ds_read_b128 v[84:87], v9 offset:64
  ds_read_b128 v[88:91], v9 offset:128
  ds_read_b128 v[92:95], v9 offset:192
  ds_read_b128 v[96:99], v9 offset:256
  ds_read_b128 v[100:103], v9 offset:320
  ds_read_b128 v[104:107], v9 offset:384
  ds_read_b128 v[108:111], v9 offset:448
  ds_read_b32 v12, v10 offset:12288
  s_waitcnt vmcnt(4)
  buffer_load_dwordx4 v[208:211], v14, s[44:47], s6 offen offset:0 sc1
  buffer_load_dwordx4 v[212:215], v14, s[44:47], s7 offen offset:0 sc1
  buffer_load_dwordx4 v[216:219], v14, s[44:47], s6 offen offset:128 sc1
  buffer_load_dwordx4 v[220:223], v14, s[44:47], s7 offen offset:128 sc1
  buffer_load_dwordx4 v[224:227], v14, s[44:47], s6 offen offset:256 sc1
  buffer_load_dwordx4 v[228:231], v14, s[44:47], s7 offen offset:256 sc1
  buffer_load_dwordx4 v[232:235], v14, s[44:47], s6 offen offset:384 sc1
  buffer_load_dwordx4 v[236:239], v14, s[44:47], s7 offen offset:384 sc1
  s_waitcnt vmcnt(8)
  s_barrier
  ds_read_b128 v[112:115], v9 offset:33280
  ds_read_b128 v[116:119], v9 offset:33344
  ds_read_b128 v[120:123], v9 offset:33408
  ds_read_b128 v[124:127], v9 offset:33472
  ds_read_b128 v[128:131], v9 offset:33536
  ds_read_b128 v[132:135], v9 offset:33600
  ds_read_b128 v[136:139], v9 offset:33664
  ds_read_b128 v[140:143], v9 offset:33728
  s_mov_b32 s78, 100000
  s_branch Lqw_56
Lqp_55:
  s_bitcmp0_b32 s13, 0
  s_cbranch_scc1 Lqg_58
  buffer_load_dwordx4 v[208:211], v14, s[44:47], s6 offen offset:0 sc1
Lqg_58:
  s_bitcmp0_b32 s13, 1
  s_cbranch_scc1 Lqg_59
  buffer_load_dwordx4 v[212:215], v14, s[44:47], s7 offen offset:0 sc1
Lqg_59:
  s_bitcmp0_b32 s13, 2
  s_cbranch_scc1 Lqg_60
  buffer_load_dwordx4 v[216:219], v14, s[44:47], s6 offen offset:128 sc1
Lqg_60:
  s_bitcmp0_b32 s13, 3
  s_cbranch_scc1 Lqg_61
  buffer_load_dwordx4 v[220:223], v14, s[44:47], s7 offen offset:128 sc1
Lqg_61:
  s_bitcmp0_b32 s13, 4
  s_cbranch_scc1 Lqg_62
  buffer_load_dwordx4 v[224:227], v14, s[44:47], s6 offen offset:256 sc1
Lqg_62:
  s_bitcmp0_b32 s13, 5
  s_cbranch_scc1 Lqg_63
  buffer_load_dwordx4 v[228:231], v14, s[44:47], s7 offen offset:256 sc1
Lqg_63:
  s_bitcmp0_b32 s13, 6
  s_cbranch_scc1 Lqg_64
  buffer_load_dwordx4 v[232:235], v14, s[44:47], s6 offen offset:384 sc1
Lqg_64:
  s_bitcmp0_b32 s13, 7
  s_cbranch_scc1 Lqg_65
  buffer_load_dwordx4 v[236:239], v14, s[44:47], s7 offen offset:384 sc1
Lqg_65:
Lqw_56:
  s_waitcnt vmcnt(0)
  v_max3_u32 v240, v208, v209, v210
  v_max3_u32 v241, v212, v213, v214
  v_max3_u32 v242, v216, v217, v218
  v_max3_u32 v243, v220, v221, v222
  v_max3_u32 v244, v224, v225, v226
  v_max3_u32 v245, v228, v229, v230
  v_max3_u32 v246, v232, v233, v234
  v_max3_u32 v247, v236, v237, v238
  v_max_u32 v240, v240, v211
  v_max_u32 v241, v241, v215
  v_max_u32 v242, v242, v219
  v_max_u32 v243, v243, v223
  v_max_u32 v244, v244, v227
  v_max_u32 v245, v245, v231
  v_max_u32 v246, v246, v235
  v_max_u32 v247, v247, v239
  v_max3_u32 v248, v240, v241, v242
  v_max3_u32 v249, v243, v244, v245
  v_max3_u32 v248, v248, v246, v247
  v_max_u32 v248, v248, v249
  v_cmp_eq_u32 vcc, -1, v248
  s_nop 3
  s_cbranch_vccz Lqd_57
  s_mov_b32 s13, 0
  v_cmp_eq_u32 vcc, -1, v240
  s_nop 0
  s_cmp_lg_u64 vcc, 0
  s_cselect_b32 s5, 1, 0
  s_or_b32 s13, s13, s5
  v_cmp_eq_u32 vcc, -1, v241
  s_nop 0
  s_cmp_lg_u64 vcc, 0
  s_cselect_b32 s5, 2, 0
  s_or_b32 s13, s13, s5
  v_cmp_eq_u32 vcc, -1, v242
  s_nop 0
  s_cmp_lg_u64 vcc, 0
  s_cselect_b32 s5, 4, 0
  s_or_b32 s13, s13, s5
  v_cmp_eq_u32 vcc, -1, v243
  s_nop 0
  s_cmp_lg_u64 vcc, 0
  s_cselect_b32 s5, 8, 0
  s_or_b32 s13, s13, s5
  v_cmp_eq_u32 vcc, -1, v244
  s_nop 0
  s_cmp_lg_u64 vcc, 0
  s_cselect_b32 s5, 16, 0
  s_or_b32 s13, s13, s5
  v_cmp_eq_u32 vcc, -1, v245
  s_nop 0
  s_cmp_lg_u64 vcc, 0
  s_cselect_b32 s5, 32, 0
  s_or_b32 s13, s13, s5
  v_cmp_eq_u32 vcc, -1, v246
  s_nop 0
  s_cmp_lg_u64 vcc, 0
  s_cselect_b32 s5, 64, 0
  s_or_b32 s13, s13, s5
  v_cmp_eq_u32 vcc, -1, v247
  s_nop 0
  s_cmp_lg_u64 vcc, 0
  s_cselect_b32 s5, 128, 0
  s_or_b32 s13, s13, s5
  s_sleep 1
  s_sub_u32 s78, s78, 1
  s_cmp_lg_u32 s78, 0
  s_cbranch_scc1 Lqp_55
Lqd_57:
  s_waitcnt lgkmcnt(0)
  v_readfirstlane_b32 s76, v12
  v_mov_b64 v[240:241], v[208:209]
  v_mov_b64 v[242:243], v[210:211]
  v_mov_b32_dpp v208, v212 row_shr:4 row_mask:0xf bank_mask:0xa
  v_mov_b32_dpp v209, v213 row_shr:4 row_mask:0xf bank_mask:0xa
  v_mov_b32_dpp v210, v214 row_shr:4 row_mask:0xf bank_mask:0xa
  v_mov_b32_dpp v211, v215 row_shr:4 row_mask:0xf bank_mask:0xa
  v_mov_b32_dpp v212, v240 row_shl:4 row_mask:0xf bank_mask:0x5
  v_mov_b32_dpp v213, v241 row_shl:4 row_mask:0xf bank_mask:0x5
  v_mov_b32_dpp v214, v242 row_shl:4 row_mask:0xf bank_mask:0x5
  v_mov_b32_dpp v215, v243 row_shl:4 row_mask:0xf bank_mask:0x5
  ds_bpermute_b32 v208, v7, v208
  ds_bpermute_b32 v209, v7, v209
  ds_bpermute_b32 v210, v7, v210
  ds_bpermute_b32 v211, v7, v211
  ds_bpermute_b32 v212, v7, v212
  ds_bpermute_b32 v213, v7, v213
  ds_bpermute_b32 v214, v7, v214
  ds_bpermute_b32 v215, v7, v215
  v_mov_b64 v[240:241], v[216:217]
  v_mov_b64 v[242:243], v[218:219]
  v_mov_b32_dpp v216, v220 row_shr:4 row_mask:0xf bank_mask:0xa
  v_mov_b32_dpp v217, v221 row_shr:4 row_mask:0xf bank_mask:0xa
  v_mov_b32_dpp v218, v222 row_shr:4 row_mask:0xf bank_mask:0xa
  v_mov_b32_dpp v219, v223 row_shr:4 row_mask:0xf bank_mask:0xa
  v_mov_b32_dpp v220, v240 row_shl:4 row_mask:0xf bank_mask:0x5
  v_mov_b32_dpp v221, v241 row_shl:4 row_mask:0xf bank_mask:0x5
  v_mov_b32_dpp v222, v242 row_shl:4 row_mask:0xf bank_mask:0x5
  v_mov_b32_dpp v223, v243 row_shl:4 row_mask:0xf bank_mask:0x5
  ds_bpermute_b32 v216, v7, v216
  ds_bpermute_b32 v217, v7, v217
  ds_bpermute_b32 v218, v7, v218
  ds_bpermute_b32 v219, v7, v219
  ds_bpermute_b32 v220, v7, v220
  ds_bpermute_b32 v221, v7, v221
  ds_bpermute_b32 v222, v7, v222
  ds_bpermute_b32 v223, v7, v223
  v_mov_b64 v[240:241], v[224:225]
  v_mov_b64 v[242:243], v[226:227]
  v_mov_b32_dpp v224, v228 row_shr:4 row_mask:0xf bank_mask:0xa
  v_mov_b32_dpp v225, v229 row_shr:4 row_mask:0xf bank_mask:0xa
  v_mov_b32_dpp v226, v230 row_shr:4 row_mask:0xf bank_mask:0xa
  v_mov_b32_dpp v227, v231 row_shr:4 row_mask:0xf bank_mask:0xa
  v_mov_b32_dpp v228, v240 row_shl:4 row_mask:0xf bank_mask:0x5
  v_mov_b32_dpp v229, v241 row_shl:4 row_mask:0xf bank_mask:0x5
  v_mov_b32_dpp v230, v242 row_shl:4 row_mask:0xf bank_mask:0x5
  v_mov_b32_dpp v231, v243 row_shl:4 row_mask:0xf bank_mask:0x5
  ds_bpermute_b32 v224, v7, v224
  ds_bpermute_b32 v225, v7, v225
  ds_bpermute_b32 v226, v7, v226
  ds_bpermute_b32 v227, v7, v227
  ds_bpermute_b32 v228, v7, v228
  ds_bpermute_b32 v229, v7, v229
  ds_bpermute_b32 v230, v7, v230
  ds_bpermute_b32 v231, v7, v231
  v_mov_b64 v[240:241], v[232:233]
  v_mov_b64 v[242:243], v[234:235]
  v_mov_b32_dpp v232, v236 row_shr:4 row_mask:0xf bank_mask:0xa
  v_mov_b32_dpp v233, v237 row_shr:4 row_mask:0xf bank_mask:0xa
  v_mov_b32_dpp v234, v238 row_shr:4 row_mask:0xf bank_mask:0xa
  v_mov_b32_dpp v235, v239 row_shr:4 row_mask:0xf bank_mask:0xa
  v_mov_b32_dpp v236, v240 row_shl:4 row_mask:0xf bank_mask:0x5
  v_mov_b32_dpp v237, v241 row_shl:4 row_mask:0xf bank_mask:0x5
  v_mov_b32_dpp v238, v242 row_shl:4 row_mask:0xf bank_mask:0x5
  v_mov_b32_dpp v239, v243 row_shl:4 row_mask:0xf bank_mask:0x5
  ds_bpermute_b32 v232, v7, v232
  ds_bpermute_b32 v233, v7, v233
  ds_bpermute_b32 v234, v7, v234
  ds_bpermute_b32 v235, v7, v235
  ds_bpermute_b32 v236, v7, v236
  ds_bpermute_b32 v237, v7, v237
  ds_bpermute_b32 v238, v7, v238
  ds_bpermute_b32 v239, v7, v239
  s_waitcnt lgkmcnt(15)
  v_mfma_f32_16x16x32_bf16 v[240:243], v[16:19], v[208:211], 0
  v_mfma_f32_16x16x32_bf16 v[244:247], v[48:51], v[208:211], 0
  v_mfma_f32_16x16x32_bf16 v[248:251], v[80:83], v[208:211], 0
  v_mfma_f32_16x16x32_bf16 v[252:255], v[112:115], v[208:211], 0
  s_waitcnt lgkmcnt(15)
  v_mfma_f32_16x16x32_bf16 v[240:243], v[20:23], v[212:215], v[240:243]
  v_mfma_f32_16x16x32_bf16 v[244:247], v[52:55], v[212:215], v[244:247]
  v_mfma_f32_16x16x32_bf16 v[248:251], v[84:87], v[212:215], v[248:251]
  v_mfma_f32_16x16x32_bf16 v[252:255], v[116:119], v[212:215], v[252:255]
  s_waitcnt lgkmcnt(15)
  v_mfma_f32_16x16x32_bf16 v[240:243], v[24:27], v[216:219], v[240:243]
  v_mfma_f32_16x16x32_bf16 v[244:247], v[56:59], v[216:219], v[244:247]
  v_mfma_f32_16x16x32_bf16 v[248:251], v[88:91], v[216:219], v[248:251]
  v_mfma_f32_16x16x32_bf16 v[252:255], v[120:123], v[216:219], v[252:255]
  s_waitcnt lgkmcnt(15)
  v_mfma_f32_16x16x32_bf16 v[240:243], v[28:31], v[220:223], v[240:243]
  v_mfma_f32_16x16x32_bf16 v[244:247], v[60:63], v[220:223], v[244:247]
  v_mfma_f32_16x16x32_bf16 v[248:251], v[92:95], v[220:223], v[248:251]
  v_mfma_f32_16x16x32_bf16 v[252:255], v[124:127], v[220:223], v[252:255]
  s_waitcnt lgkmcnt(12)
  v_mfma_f32_16x16x32_bf16 v[240:243], v[32:35], v[224:227], v[240:243]
  v_mfma_f32_16x16x32_bf16 v[244:247], v[64:67], v[224:227], v[244:247]
  v_mfma_f32_16x16x32_bf16 v[248:251], v[96:99], v[224:227], v[248:251]
  v_mfma_f32_16x16x32_bf16 v[252:255], v[128:131], v[224:227], v[252:255]
  s_waitcnt lgkmcnt(8)
  v_mfma_f32_16x16x32_bf16 v[240:243], v[36:39], v[228:231], v[240:243]
  v_mfma_f32_16x16x32_bf16 v[244:247], v[68:71], v[228:231], v[244:247]
  v_mfma_f32_16x16x32_bf16 v[248:251], v[100:103], v[228:231], v[248:251]
  v_mfma_f32_16x16x32_bf16 v[252:255], v[132:135], v[228:231], v[252:255]
  s_waitcnt lgkmcnt(4)
  v_mfma_f32_16x16x32_bf16 v[240:243], v[40:43], v[232:235], v[240:243]
  v_mfma_f32_16x16x32_bf16 v[244:247], v[72:75], v[232:235], v[244:247]
  v_mfma_f32_16x16x32_bf16 v[248:251], v[104:107], v[232:235], v[248:251]
  v_mfma_f32_16x16x32_bf16 v[252:255], v[136:139], v[232:235], v[252:255]
  s_waitcnt lgkmcnt(0)
  v_mfma_f32_16x16x32_bf16 v[240:243], v[44:47], v[236:239], v[240:243]
  v_mfma_f32_16x16x32_bf16 v[244:247], v[76:79], v[236:239], v[244:247]
  v_mfma_f32_16x16x32_bf16 v[248:251], v[108:111], v[236:239], v[248:251]
  v_mfma_f32_16x16x32_bf16 v[252:255], v[140:143], v[236:239], v[252:255]
  s_cmp_eq_u32 s3, 1
  s_nop 5
  s_cbranch_scc1 Lsxw_68
  s_cmp_eq_u32 s3, 2
  s_cbranch_scc1 Lsxw_69
  s_cmp_eq_u32 s3, 3
  s_cbranch_scc1 Lsxw_70
Lsxw_67:
  ds_write_b128 v10, v[244:247] offset:5120
  ds_write_b128 v10, v[248:251] offset:7168
  ds_write_b128 v10, v[252:255] offset:9216
  v_mov_b64 v[208:209], v[240:241]
  v_mov_b64 v[210:211], v[242:243]
  s_nop 0
  s_branch Lsx_66
Lsxw_68:
  ds_write_b128 v10, v[240:243] offset:0
  ds_write_b128 v10, v[248:251] offset:8192
  ds_write_b128 v10, v[252:255] offset:10240
  v_mov_b64 v[208:209], v[244:245]
  v_mov_b64 v[210:211], v[246:247]
  s_nop 0
  s_branch Lsx_66
Lsxw_69:
  ds_write_b128 v10, v[240:243] offset:1024
  ds_write_b128 v10, v[244:247] offset:3072
  ds_write_b128 v10, v[252:255] offset:11264
  v_mov_b64 v[208:209], v[248:249]
  v_mov_b64 v[210:211], v[250:251]
  s_nop 0
  s_branch Lsx_66
Lsxw_70:
  ds_write_b128 v10, v[240:243] offset:2048
  ds_write_b128 v10, v[244:247] offset:4096
  ds_write_b128 v10, v[248:251] offset:6144
  v_mov_b64 v[208:209], v[252:253]
  v_mov_b64 v[210:211], v[254:255]
Lsx_66:
  s_mul_i32 s5, s3, 3072
  v_add_u32 v13, s5, v10
  s_waitcnt lgkmcnt(0)
  s_barrier
  ds_read_b128 v[212:215], v13 offset:0
  ds_read_b128 v[216:219], v13 offset:1024
  ds_read_b128 v[220:223], v13 offset:2048
  ds_read_b64_tr_b16 v[16:17], v8 offset:0
  ds_read_b64_tr_b16 v[20:21], v8 offset:32
  ds_read_b64_tr_b16 v[24:25], v8 offset:64
  ds_read_b64_tr_b16 v[28:29], v8 offset:96
  ds_read_b64_tr_b16 v[32:33], v8 offset:128
  ds_read_b64_tr_b16 v[36:37], v8 offset:160
  ds_read_b64_tr_b16 v[40:41], v8 offset:192
  ds_read_b64_tr_b16 v[44:45], v8 offset:224
  ds_read_b64_tr_b16 v[48:49], v8 offset:256
  ds_read_b64_tr_b16 v[52:53], v8 offset:288
  ds_read_b64_tr_b16 v[56:57], v8 offset:320
  ds_read_b64_tr_b16 v[60:61], v8 offset:352
  ds_read_b64_tr_b16 v[64:65], v8 offset:384
  ds_read_b64_tr_b16 v[68:69], v8 offset:416
  ds_read_b64_tr_b16 v[72:73], v8 offset:448
  ds_read_b64_tr_b16 v[76:77], v8 offset:480
  s_waitcnt lgkmcnt(15)
  s_waitcnt lgkmcnt(14)
  v_pk_add_f32 v[208:209], v[208:209], v[212:213]
  v_pk_add_f32 v[210:211], v[210:211], v[214:215]
  v_pk_add_f32 v[216:217], v[216:217], v[220:221]
  v_pk_add_f32 v[218:219], v[218:219], v[222:223]
  v_pk_add_f32 v[208:209], v[208:209], v[216:217]
  v_pk_add_f32 v[210:211], v[210:211], v[218:219]
  ds_write_b128 v13, v[208:211]
  s_waitcnt lgkmcnt(0)
  s_barrier
  ds_read_b128 v[240:243], v10 offset:0
  ds_read_b128 v[244:247], v10 offset:3072
  ds_read_b128 v[248:251], v10 offset:6144
  ds_read_b128 v[252:255], v10 offset:9216
  s_waitcnt lgkmcnt(0)
  ds_read_b64_tr_b16 v[18:19], v8 offset:33280
  ds_read_b64_tr_b16 v[22:23], v8 offset:33312
  ds_read_b64_tr_b16 v[26:27], v8 offset:33344
  ds_read_b64_tr_b16 v[30:31], v8 offset:33376
  ds_read_b64_tr_b16 v[34:35], v8 offset:33408
  ds_read_b64_tr_b16 v[38:39], v8 offset:33440
  ds_read_b64_tr_b16 v[42:43], v8 offset:33472
  ds_read_b64_tr_b16 v[46:47], v8 offset:33504
  ds_read_b64_tr_b16 v[50:51], v8 offset:33536
  ds_read_b64_tr_b16 v[54:55], v8 offset:33568
  ds_read_b64_tr_b16 v[58:59], v8 offset:33600
  ds_read_b64_tr_b16 v[62:63], v8 offset:33632
  ds_read_b64_tr_b16 v[66:67], v8 offset:33664
  ds_read_b64_tr_b16 v[70:71], v8 offset:33696
  ds_read_b64_tr_b16 v[74:75], v8 offset:33728
  ds_read_b64_tr_b16 v[78:79], v8 offset:33760
  v_max3_f32 v216, v240, v241, v242
  v_max3_f32 v216, v216, v243, v244
  v_max3_f32 v216, v216, v245, v246
  v_max3_f32 v216, v216, v247, v248
  v_max3_f32 v216, v216, v249, v250
  v_max3_f32 v216, v216, v251, v252
  v_max3_f32 v216, v216, v253, v254
  v_max3_f32 v216, v216, v255, v255
  v_mov_b32 v220, v216
  s_nop 1
  v_permlane32_swap_b32 v216, v220
  v_max_f32 v216, v216, v220
  v_mov_b32 v220, v216
  s_nop 1
  v_permlane16_swap_b32 v216, v220
  v_max_f32 v216, v216, v220
  s_mov_b32 s5, 0x3db8aa3b
  v_mul_f32 v216, s5, v216
  v_fma_f32 v240, v240, s5, -v216
  v_fma_f32 v241, v241, s5, -v216
  v_fma_f32 v242, v242, s5, -v216
  v_fma_f32 v243, v243, s5, -v216
  v_fma_f32 v244, v244, s5, -v216
  v_fma_f32 v245, v245, s5, -v216
  v_fma_f32 v246, v246, s5, -v216
  v_fma_f32 v247, v247, s5, -v216
  v_fma_f32 v248, v248, s5, -v216
  v_fma_f32 v249, v249, s5, -v216
  v_fma_f32 v250, v250, s5, -v216
  v_fma_f32 v251, v251, s5, -v216
  v_fma_f32 v252, v252, s5, -v216
  v_fma_f32 v253, v253, s5, -v216
  v_fma_f32 v254, v254, s5, -v216
  v_fma_f32 v255, v255, s5, -v216
  v_exp_f32 v240, v240
  v_exp_f32 v241, v241
  v_exp_f32 v242, v242
  v_exp_f32 v243, v243
  v_exp_f32 v244, v244
  v_exp_f32 v245, v245
  v_exp_f32 v246, v246
  v_exp_f32 v247, v247
  v_exp_f32 v248, v248
  v_exp_f32 v249, v249
  v_exp_f32 v250, v250
  v_exp_f32 v251, v251
  v_exp_f32 v252, v252
  v_exp_f32 v253, v253
  v_exp_f32 v254, v254
  v_exp_f32 v255, v255
  v_cvt_pk_bf16_f32 v208, v240, v241
  v_cvt_pk_bf16_f32 v209, v242, v243
  v_cvt_pk_bf16_f32 v210, v244, v245
  v_cvt_pk_bf16_f32 v211, v246, v247
  v_cvt_pk_bf16_f32 v212, v248, v249
  v_cvt_pk_bf16_f32 v213, v250, v251
  v_cvt_pk_bf16_f32 v214, v252, v253
  v_cvt_pk_bf16_f32 v215, v254, v255
  v_and_b32 v13, 15, v1
  v_mul_u32_u24 v13, 2080, v13
  v_lshrrev_b32 v14, 4, v1
  v_bfe_u32 v7, v1, 2, 2
  v_xor_b32 v14, v14, v7
  v_lshl_add_u32 v13, v14, 3, v13
  s_lshl_b32 s5, s3, 9
  v_add_u32 v13, s5, v13
  v_lshrrev_b32 v14, 5, v1
  v_mul_u32_u24 v14, 2080, v14
  v_and_b32 v7, 31, v1
  v_lshl_add_u32 v14, v7, 4, v14
  v_add_u32 v14, s5, v14
  v_xor_b32 v7, 16, v14
  s_waitcnt lgkmcnt(0)
  v_mfma_f32_16x16x32_bf16 v[80:83], v[144:147], v[208:211], 0
  v_mfma_f32_16x16x32_bf16 v[80:83], v[16:19], v[212:215], v[80:83]
  s_cmp_lg_u32 s3, 0
  s_nop 5
  s_cbranch_scc1 Lst3_71
  v_pk_add_f32 v[240:241], v[240:241], v[248:249]
  v_pk_add_f32 v[242:243], v[242:243], v[250:251]
  v_pk_add_f32 v[244:245], v[244:245], v[252:253]
  v_pk_add_f32 v[246:247], v[246:247], v[254:255]
  v_pk_add_f32 v[240:241], v[240:241], v[244:245]
  v_pk_add_f32 v[242:243], v[242:243], v[246:247]
  v_pk_add_f32 v[240:241], v[240:241], v[242:243]
  v_add_f32 v218, v240, v241
  v_mov_b32 v220, v218
  s_nop 1
  v_permlane32_swap_b32 v218, v220
  v_add_f32 v218, v218, v220
  v_mov_b32 v220, v218
  s_nop 1
  v_permlane16_swap_b32 v218, v220
  v_add_f32 v218, v218, v220
  v_mov_b32 v217, s76
  v_mov_b32 v219, s76
  v_lshlrev_b32 v220, 11, v1
  s_lshl_b32 s5, s11, 4
  s_add_u32 s5, s5, 196608
  s_mov_b32 exec_lo, 0xffff
  s_mov_b32 exec_hi, 0x0
  buffer_store_dwordx4 v[216:219], v220, s[44:47], s5 offen sc1
  s_mov_b64 exec, -1
Lst3_71:
  v_mfma_f32_16x16x32_bf16 v[84:87], v[148:151], v[208:211], 0
  v_mfma_f32_16x16x32_bf16 v[84:87], v[20:23], v[212:215], v[84:87]
  v_mfma_f32_16x16x32_bf16 v[88:91], v[152:155], v[208:211], 0
  v_mfma_f32_16x16x32_bf16 v[88:91], v[24:27], v[212:215], v[88:91]
  v_mfma_f32_16x16x32_bf16 v[92:95], v[156:159], v[208:211], 0
  v_mfma_f32_16x16x32_bf16 v[92:95], v[28:31], v[212:215], v[92:95]
  v_cvt_pk_bf16_f32 v80, v80, v81
  v_cvt_pk_bf16_f32 v81, v82, v83
  ds_write_b64 v13, v[80:81] offset:0
  v_mfma_f32_16x16x32_bf16 v[96:99], v[160:163], v[208:211], 0
  v_mfma_f32_16x16x32_bf16 v[96:99], v[32:35], v[212:215], v[96:99]
  v_cvt_pk_bf16_f32 v84, v84, v85
  v_cvt_pk_bf16_f32 v85, v86, v87
  ds_write_b64 v13, v[84:85] offset:32
  v_mfma_f32_16x16x32_bf16 v[100:103], v[164:167], v[208:211], 0
  v_mfma_f32_16x16x32_bf16 v[100:103], v[36:39], v[212:215], v[100:103]
  v_cvt_pk_bf16_f32 v88, v88, v89
  v_cvt_pk_bf16_f32 v89, v90, v91
  ds_write_b64 v13, v[88:89] offset:64
  v_mfma_f32_16x16x32_bf16 v[104:107], v[168:171], v[208:211], 0
  v_mfma_f32_16x16x32_bf16 v[104:107], v[40:43], v[212:215], v[104:107]
  v_cvt_pk_bf16_f32 v92, v92, v93
  v_cvt_pk_bf16_f32 v93, v94, v95
  ds_write_b64 v13, v[92:93] offset:96
  v_mfma_f32_16x16x32_bf16 v[108:111], v[172:175], v[208:211], 0
  v_mfma_f32_16x16x32_bf16 v[108:111], v[44:47], v[212:215], v[108:111]
  v_cvt_pk_bf16_f32 v96, v96, v97
  v_cvt_pk_bf16_f32 v97, v98, v99
  ds_write_b64 v13, v[96:97] offset:128
  v_mfma_f32_16x16x32_bf16 v[112:115], v[176:179], v[208:211], 0
  v_mfma_f32_16x16x32_bf16 v[112:115], v[48:51], v[212:215], v[112:115]
  v_cvt_pk_bf16_f32 v100, v100, v101
  v_cvt_pk_bf16_f32 v101, v102, v103
  ds_write_b64 v13, v[100:101] offset:160
  v_mfma_f32_16x16x32_bf16 v[116:119], v[180:183], v[208:211], 0
  v_mfma_f32_16x16x32_bf16 v[116:119], v[52:55], v[212:215], v[116:119]
  v_cvt_pk_bf16_f32 v104, v104, v105
  v_cvt_pk_bf16_f32 v105, v106, v107
  ds_write_b64 v13, v[104:105] offset:192
  v_mfma_f32_16x16x32_bf16 v[120:123], v[184:187], v[208:211], 0
  v_mfma_f32_16x16x32_bf16 v[120:123], v[56:59], v[212:215], v[120:123]
  v_cvt_pk_bf16_f32 v108, v108, v109
  v_cvt_pk_bf16_f32 v109, v110, v111
  ds_write_b64 v13, v[108:109] offset:224
  v_mfma_f32_16x16x32_bf16 v[124:127], v[188:191], v[208:211], 0
  v_mfma_f32_16x16x32_bf16 v[124:127], v[60:63], v[212:215], v[124:127]
  v_cvt_pk_bf16_f32 v112, v112, v113
  v_cvt_pk_bf16_f32 v113, v114, v115
  ds_write_b64 v13, v[112:113] offset:256
  v_mfma_f32_16x16x32_bf16 v[128:131], v[192:195], v[208:211], 0
  v_mfma_f32_16x16x32_bf16 v[128:131], v[64:67], v[212:215], v[128:131]
  v_cvt_pk_bf16_f32 v116, v116, v117
  v_cvt_pk_bf16_f32 v117, v118, v119
  ds_write_b64 v13, v[116:117] offset:288
  v_mfma_f32_16x16x32_bf16 v[132:135], v[196:199], v[208:211], 0
  v_mfma_f32_16x16x32_bf16 v[132:135], v[68:71], v[212:215], v[132:135]
  v_cvt_pk_bf16_f32 v120, v120, v121
  v_cvt_pk_bf16_f32 v121, v122, v123
  ds_write_b64 v13, v[120:121] offset:320
  v_mfma_f32_16x16x32_bf16 v[136:139], v[200:203], v[208:211], 0
  v_mfma_f32_16x16x32_bf16 v[136:139], v[72:75], v[212:215], v[136:139]
  v_cvt_pk_bf16_f32 v124, v124, v125
  v_cvt_pk_bf16_f32 v125, v126, v127
  ds_write_b64 v13, v[124:125] offset:352
  v_mfma_f32_16x16x32_bf16 v[140:143], v[204:207], v[208:211], 0
  v_mfma_f32_16x16x32_bf16 v[140:143], v[76:79], v[212:215], v[140:143]
  v_cvt_pk_bf16_f32 v128, v128, v129
  v_cvt_pk_bf16_f32 v129, v130, v131
  ds_write_b64 v13, v[128:129] offset:384
  v_cvt_pk_bf16_f32 v132, v132, v133
  v_cvt_pk_bf16_f32 v133, v134, v135
  ds_write_b64 v13, v[132:133] offset:416
  v_cvt_pk_bf16_f32 v136, v136, v137
  v_cvt_pk_bf16_f32 v137, v138, v139
  ds_write_b64 v13, v[136:137] offset:448
  v_cvt_pk_bf16_f32 v140, v140, v141
  v_cvt_pk_bf16_f32 v141, v142, v143
  ds_write_b64 v13, v[140:141] offset:480
  s_waitcnt lgkmcnt(0)
  ds_read_b128 v[16:19], v14 offset:0
  ds_read_b128 v[20:23], v14 offset:4160
  ds_read_b64 v[26:27], v14 offset:8320
  ds_read_b64 v[24:25], v14 offset:8328
  ds_read_b64 v[30:31], v14 offset:12480
  ds_read_b64 v[28:29], v14 offset:12488
  ds_read_b128 v[32:35], v7 offset:16640
  ds_read_b128 v[36:39], v7 offset:20800
  ds_read_b64 v[42:43], v7 offset:24960
  ds_read_b64 v[40:41], v7 offset:24968
  ds_read_b64 v[46:47], v7 offset:29120
  ds_read_b64 v[44:45], v7 offset:29128
  v_and_b32 v13, 15, v1
  v_lshlrev_b32 v13, 1, v13
  s_waitcnt lgkmcnt(11)
  v_and_b32 v16, -4, v16
  v_add3_u32 v80, v17, v18, v19
  v_add_u32 v80, v80, v16
  s_waitcnt lgkmcnt(10)
  v_and_b32 v20, -4, v20
  v_add3_u32 v81, v21, v22, v23
  v_add_u32 v81, v81, v20
  s_waitcnt lgkmcnt(8)
  v_and_b32 v24, -4, v24
  v_add3_u32 v82, v25, v26, v27
  v_add_u32 v82, v82, v24
  s_waitcnt lgkmcnt(6)
  v_and_b32 v28, -4, v28
  v_add3_u32 v83, v29, v30, v31
  v_add_u32 v83, v83, v28
  s_waitcnt lgkmcnt(5)
  v_and_b32 v32, -4, v32
  v_add3_u32 v84, v33, v34, v35
  v_add_u32 v84, v84, v32
  s_waitcnt lgkmcnt(4)
  v_and_b32 v36, -4, v36
  v_add3_u32 v85, v37, v38, v39
  v_add_u32 v85, v85, v36
  s_waitcnt lgkmcnt(2)
  v_and_b32 v40, -4, v40
  v_add3_u32 v86, v41, v42, v43
  v_add_u32 v86, v86, v40
  s_waitcnt lgkmcnt(0)
  v_and_b32 v44, -4, v44
  v_add3_u32 v87, v45, v46, v47
  v_add_u32 v87, v87, v44
  v_add_u32_dpp v80, v80, v80 quad_perm:[1,0,3,2] row_mask:0xf bank_mask:0xf
  v_add_u32_dpp v81, v81, v81 quad_perm:[1,0,3,2] row_mask:0xf bank_mask:0xf
  v_add_u32_dpp v82, v82, v82 quad_perm:[1,0,3,2] row_mask:0xf bank_mask:0xf
  v_add_u32_dpp v83, v83, v83 quad_perm:[1,0,3,2] row_mask:0xf bank_mask:0xf
  v_add_u32_dpp v84, v84, v84 quad_perm:[1,0,3,2] row_mask:0xf bank_mask:0xf
  v_add_u32_dpp v85, v85, v85 quad_perm:[1,0,3,2] row_mask:0xf bank_mask:0xf
  v_add_u32_dpp v86, v86, v86 quad_perm:[1,0,3,2] row_mask:0xf bank_mask:0xf
  v_add_u32_dpp v87, v87, v87 quad_perm:[1,0,3,2] row_mask:0xf bank_mask:0xf
  v_add_u32_dpp v80, v80, v80 quad_perm:[2,3,0,1] row_mask:0xf bank_mask:0xf
  v_add_u32_dpp v81, v81, v81 quad_perm:[2,3,0,1] row_mask:0xf bank_mask:0xf
  v_add_u32_dpp v82, v82, v82 quad_perm:[2,3,0,1] row_mask:0xf bank_mask:0xf
  v_add_u32_dpp v83, v83, v83 quad_perm:[2,3,0,1] row_mask:0xf bank_mask:0xf
  v_add_u32_dpp v84, v84, v84 quad_perm:[2,3,0,1] row_mask:0xf bank_mask:0xf
  v_add_u32_dpp v85, v85, v85 quad_perm:[2,3,0,1] row_mask:0xf bank_mask:0xf
  v_add_u32_dpp v86, v86, v86 quad_perm:[2,3,0,1] row_mask:0xf bank_mask:0xf
  v_add_u32_dpp v87, v87, v87 quad_perm:[2,3,0,1] row_mask:0xf bank_mask:0xf
  v_add_u32_dpp v80, v80, v80 row_half_mirror row_mask:0xf bank_mask:0xf
  v_add_u32_dpp v81, v81, v81 row_half_mirror row_mask:0xf bank_mask:0xf
  v_add_u32_dpp v82, v82, v82 row_half_mirror row_mask:0xf bank_mask:0xf
  v_add_u32_dpp v83, v83, v83 row_half_mirror row_mask:0xf bank_mask:0xf
  v_add_u32_dpp v84, v84, v84 row_half_mirror row_mask:0xf bank_mask:0xf
  v_add_u32_dpp v85, v85, v85 row_half_mirror row_mask:0xf bank_mask:0xf
  v_add_u32_dpp v86, v86, v86 row_half_mirror row_mask:0xf bank_mask:0xf
  v_add_u32_dpp v87, v87, v87 row_half_mirror row_mask:0xf bank_mask:0xf
  v_add_u32_dpp v80, v80, v80 row_mirror row_mask:0xf bank_mask:0xf
  v_add_u32_dpp v81, v81, v81 row_mirror row_mask:0xf bank_mask:0xf
  v_add_u32_dpp v82, v82, v82 row_mirror row_mask:0xf bank_mask:0xf
  v_add_u32_dpp v83, v83, v83 row_mirror row_mask:0xf bank_mask:0xf
  v_add_u32_dpp v84, v84, v84 row_mirror row_mask:0xf bank_mask:0xf
  v_add_u32_dpp v85, v85, v85 row_mirror row_mask:0xf bank_mask:0xf
  v_add_u32_dpp v86, v86, v86 row_mirror row_mask:0xf bank_mask:0xf
  v_add_u32_dpp v87, v87, v87 row_mirror row_mask:0xf bank_mask:0xf
  v_add_u32 v80, s76, v80
  v_bfe_u32 v80, v80, v13, 2
  v_or_b32 v16, v16, v80
  s_add_u32 s79, s10, 0
  buffer_store_dwordx4 v[16:19], v15, s[44:47], s79 offen sc1
  v_add_u32 v81, s76, v81
  v_bfe_u32 v81, v81, v13, 2
  v_or_b32 v20, v20, v81
  s_add_u32 s79, s10, 528384
  buffer_store_dwordx4 v[20:23], v15, s[44:47], s79 offen sc1
  v_add_u32 v82, s76, v82
  v_bfe_u32 v82, v82, v13, 2
  v_or_b32 v24, v24, v82
  s_add_u32 s79, s10, 1056768
  buffer_store_dwordx4 v[24:27], v15, s[44:47], s79 offen sc1
  v_add_u32 v83, s76, v83
  v_bfe_u32 v83, v83, v13, 2
  v_or_b32 v28, v28, v83
  s_add_u32 s79, s10, 1585152
  buffer_store_dwordx4 v[28:31], v15, s[44:47], s79 offen sc1
  v_add_u32 v84, s76, v84
  v_bfe_u32 v84, v84, v13, 2
  v_or_b32 v32, v32, v84
  s_add_u32 s79, s10, 2113536
  buffer_store_dwordx4 v[32:35], v15, s[44:47], s79 offen sc1
  v_add_u32 v85, s76, v85
  v_bfe_u32 v85, v85, v13, 2
  v_or_b32 v36, v36, v85
  s_add_u32 s79, s10, 2641920
  buffer_store_dwordx4 v[36:39], v15, s[44:47], s79 offen sc1
  v_add_u32 v86, s76, v86
  v_bfe_u32 v86, v86, v13, 2
  v_or_b32 v40, v40, v86
  s_add_u32 s79, s10, 3170304
  buffer_store_dwordx4 v[40:43], v15, s[44:47], s79 offen sc1
  v_add_u32 v87, s76, v87
  v_bfe_u32 v87, v87, v13, 2
  v_or_b32 v44, v44, v87
  s_add_u32 s79, s10, 3698688
  buffer_store_dwordx4 v[44:47], v15, s[44:47], s79 offen sc1
  s_mov_b32 s14, s3
  s_mul_i32 s15, s11, 28672
  v_bfe_u32 v13, v1, 4, 1
  v_lshlrev_b32 v13, 4, v13
  v_lshrrev_b32 v14, 5, v1
  v_add_u32 v13, v13, v14
  v_mul_u32_u24 v13, 896, v13
  v_and_b32 v14, 15, v1
  v_lshl_add_u32 v13, v14, 4, v13
  s_lshl_b32 s5, s14, 8
  s_add_u32 s15, s15, s5
  s_cmp_eq_u32 s14, 3
  s_cselect_b32 s82, 0x00ff00ff, -1
  s_lshr_b32 s12, s11, 3
  s_and_b32 s13, s11, 7
  v_lshrrev_b32 v7, 4, v1
  v_lshlrev_b32 v7, 11, v7
  v_and_b32 v14, 15, v1
  v_lshl_add_u32 v7, v14, 4, v7
  s_lshl_b32 s5, s12, 14
  s_lshl_b32 s6, s13, 8
  s_add_u32 s5, s5, s6
  s_add_u32 s5, s5, 262144
  s_add_u32 s6, s5, 8192
  s_cmp_lg_u32 s3, 0
  s_cbranch_scc1 Lx1w_72
  s_mov_b32 s78, 2000
  s_add_u32 s64, s5, 4
  s_add_u32 s65, s5, 4100
  s_add_u32 s66, s5, 8196
  s_add_u32 s67, s5, 12292
Lsp_73:
  s_load_dword s68, s[42:43], s64 glc
  s_load_dword s69, s[42:43], s65 glc
  s_load_dword s70, s[42:43], s66 glc
  s_load_dword s71, s[42:43], s67 glc
  s_waitcnt lgkmcnt(0)
  s_mov_b32 s83, 0
  s_cmp_eq_u32 s68, s76
  s_addc_u32 s83, s83, 0
  s_cmp_eq_u32 s69, s76
  s_addc_u32 s83, s83, 0
  s_cmp_eq_u32 s70, s76
  s_addc_u32 s83, s83, 0
  s_cmp_eq_u32 s71, s76
  s_addc_u32 s83, s83, 0
  s_cmp_ge_u32 s83, 3
  s_cbranch_scc1 Lspd_74
  s_sleep 6
  s_sub_u32 s78, s78, 1
  s_cmp_lg_u32 s78, 0
  s_cbranch_scc1 Lsp_73
Lspd_74:
Lx1w_72:
  s_barrier
  s_mov_b32 exec_lo, s82
  s_mov_b32 exec_hi, s82
  s_add_u32 s79, s15, 0
  buffer_load_dwordx4 v[144:147], v13, s[56:59], s79 offen offset:0 nt
  s_mov_b64 exec, -1
  s_mov_b32 exec_lo, s82
  s_mov_b32 exec_hi, s82
  s_add_u32 s79, s15, 0
  buffer_load_dwordx4 v[148:151], v13, s[56:59], s79 offen offset:1792 nt
  s_mov_b64 exec, -1
  s_mov_b32 exec_lo, s82
  s_mov_b32 exec_hi, s82
  s_add_u32 s79, s15, 3584
  buffer_load_dwordx4 v[152:155], v13, s[56:59], s79 offen offset:0 nt
  s_mov_b64 exec, -1
  s_mov_b32 exec_lo, s82
  s_mov_b32 exec_hi, s82
  s_add_u32 s79, s15, 3584
  buffer_load_dwordx4 v[156:159], v13, s[56:59], s79 offen offset:1792 nt
  s_mov_b64 exec, -1
  s_mov_b32 exec_lo, s82
  s_mov_b32 exec_hi, s82
  s_add_u32 s79, s15, 7168
  buffer_load_dwordx4 v[160:163], v13, s[56:59], s79 offen offset:0 nt
  s_mov_b64 exec, -1
  s_mov_b32 exec_lo, s82
  s_mov_b32 exec_hi, s82
  s_add_u32 s79, s15, 7168
  buffer_load_dwordx4 v[164:167], v13, s[56:59], s79 offen offset:1792 nt
  s_mov_b64 exec, -1
  s_mov_b32 exec_lo, s82
  s_mov_b32 exec_hi, s82
  s_add_u32 s79, s15, 10752
  buffer_load_dwordx4 v[168:171], v13, s[56:59], s79 offen offset:0 nt
  s_mov_b64 exec, -1
  s_mov_b32 exec_lo, s82
  s_mov_b32 exec_hi, s82
  s_add_u32 s79, s15, 10752
  buffer_load_dwordx4 v[172:175], v13, s[56:59], s79 offen offset:1792 nt
  s_mov_b64 exec, -1
  s_mov_b32 s78, 2000
  s_add_u32 s64, s5, 4
  s_add_u32 s65, s5, 4100
  s_add_u32 s66, s5, 8196
Lsp_75:
  s_load_dword s68, s[42:43], s64 glc
  s_load_dword s69, s[42:43], s65 glc
  s_load_dword s70, s[42:43], s66 glc
  s_waitcnt lgkmcnt(0)
  s_mov_b32 s83, 0
  s_cmp_eq_u32 s68, s76
  s_addc_u32 s83, s83, 0
  s_cmp_eq_u32 s69, s76
  s_addc_u32 s83, s83, 0
  s_cmp_eq_u32 s70, s76
  s_addc_u32 s83, s83, 0
  s_cmp_ge_u32 s83, 3
  s_cbranch_scc1 Lspd_76
  s_sleep 2
  s_sub_u32 s78, s78, 1
  s_cmp_lg_u32 s78, 0
  s_cbranch_scc1 Lsp_75
Lspd_76:
  s_mov_b32 s78, 100000
Lpoll_77:
  buffer_load_dwordx4 v[48:51], v7, s[44:47], s5 offen sc1
  buffer_load_dwordx4 v[52:55], v7, s[44:47], s6 offen sc1
Lpw_78:
  s_waitcnt vmcnt(0)
  v_bitop3_b32 v56, v49, v51, s76 bitop3:0x7e
  v_bitop3_b32 v57, v53, v55, s76 bitop3:0x7e
  v_or3_b32 v56, v56, v57, v57
  v_cmp_ne_u32 vcc, 0, v56
  s_nop 0
  s_cmp_eq_u64 vcc, 0
  s_nop 1
  s_cbranch_scc1 Lpd_79
  s_sleep 2
  s_sub_u32 s78, s78, 1
  s_cmp_lg_u32 s78, 0
  s_cbranch_scc1 Lpoll_77
Lpd_79:
  v_add_f32 v48, v48, v52
  v_add_f32 v49, v50, v54
  s_mul_i32 s15, s11, 4224
  s_lshl_b32 s5, s3, 10
  s_add_u32 s15, s15, s5
  s_add_u32 s15, s15, 2637824
  v_permlane32_swap_b32 v48, v49
  v_add_f32 v48, v48, v49
  v_mov_b32 v49, v48
  s_nop 1
  v_permlane16_swap_b32 v48, v49
  v_add_f32 v48, v48, v49
  v_cvt_pk_bf16_f32 v48, v48, v48
  v_mov_b32 v49, v48
  s_nop 1
  v_mov_b32_dpp v48, v49 row_ror:8 row_mask:0xa bank_mask:0xf
  s_nop 1
  v_and_b32_dpp v208, v48, v2 row_newbcast:0 row_mask:0xf bank_mask:0xf
  v_and_b32_dpp v209, v48, v3 row_newbcast:0 row_mask:0xf bank_mask:0xf
  v_and_b32_dpp v210, v48, v4 row_newbcast:0 row_mask:0xf bank_mask:0xf
  v_and_b32_dpp v211, v48, v5 row_newbcast:0 row_mask:0xf bank_mask:0xf
  s_nop 1
  v_mfma_f32_16x16x32_bf16 v[216:219], v[208:211], v[144:147], 0
  v_and_b32_dpp v212, v48, v2 row_newbcast:1 row_mask:0xf bank_mask:0xf
  v_and_b32_dpp v213, v48, v3 row_newbcast:1 row_mask:0xf bank_mask:0xf
  v_and_b32_dpp v214, v48, v4 row_newbcast:1 row_mask:0xf bank_mask:0xf
  v_and_b32_dpp v215, v48, v5 row_newbcast:1 row_mask:0xf bank_mask:0xf
  s_nop 1
  v_mfma_f32_16x16x32_bf16 v[216:219], v[212:215], v[148:151], v[216:219]
  v_and_b32_dpp v208, v48, v2 row_newbcast:2 row_mask:0xf bank_mask:0xf
  v_and_b32_dpp v209, v48, v3 row_newbcast:2 row_mask:0xf bank_mask:0xf
  v_and_b32_dpp v210, v48, v4 row_newbcast:2 row_mask:0xf bank_mask:0xf
  v_and_b32_dpp v211, v48, v5 row_newbcast:2 row_mask:0xf bank_mask:0xf
  s_nop 1
  v_mfma_f32_16x16x32_bf16 v[216:219], v[208:211], v[152:155], v[216:219]
  v_and_b32_dpp v212, v48, v2 row_newbcast:3 row_mask:0xf bank_mask:0xf
  v_and_b32_dpp v213, v48, v3 row_newbcast:3 row_mask:0xf bank_mask:0xf
  v_and_b32_dpp v214, v48, v4 row_newbcast:3 row_mask:0xf bank_mask:0xf
  v_and_b32_dpp v215, v48, v5 row_newbcast:3 row_mask:0xf bank_mask:0xf
  s_nop 1
  v_mfma_f32_16x16x32_bf16 v[216:219], v[212:215], v[156:159], v[216:219]
  v_and_b32_dpp v208, v48, v2 row_newbcast:4 row_mask:0xf bank_mask:0xf
  v_and_b32_dpp v209, v48, v3 row_newbcast:4 row_mask:0xf bank_mask:0xf
  v_and_b32_dpp v210, v48, v4 row_newbcast:4 row_mask:0xf bank_mask:0xf
  v_and_b32_dpp v211, v48, v5 row_newbcast:4 row_mask:0xf bank_mask:0xf
  s_nop 1
  v_mfma_f32_16x16x32_bf16 v[216:219], v[208:211], v[160:163], v[216:219]
  v_and_b32_dpp v212, v48, v2 row_newbcast:5 row_mask:0xf bank_mask:0xf
  v_and_b32_dpp v213, v48, v3 row_newbcast:5 row_mask:0xf bank_mask:0xf
  v_and_b32_dpp v214, v48, v4 row_newbcast:5 row_mask:0xf bank_mask:0xf
  v_and_b32_dpp v215, v48, v5 row_newbcast:5 row_mask:0xf bank_mask:0xf
  s_nop 1
  v_mfma_f32_16x16x32_bf16 v[216:219], v[212:215], v[164:167], v[216:219]
  v_and_b32_dpp v208, v48, v2 row_newbcast:6 row_mask:0xf bank_mask:0xf
  v_and_b32_dpp v209, v48, v3 row_newbcast:6 row_mask:0xf bank_mask:0xf
  v_and_b32_dpp v210, v48, v4 row_newbcast:6 row_mask:0xf bank_mask:0xf
  v_and_b32_dpp v211, v48, v5 row_newbcast:6 row_mask:0xf bank_mask:0xf
  s_nop 1
  v_mfma_f32_16x16x32_bf16 v[216:219], v[208:211], v[168:171], v[216:219]
  v_and_b32_dpp v212, v48, v2 row_newbcast:7 row_mask:0xf bank_mask:0xf
  v_and_b32_dpp v213, v48, v3 row_newbcast:7 row_mask:0xf bank_mask:0xf
  v_and_b32_dpp v214, v48, v4 row_newbcast:7 row_mask:0xf bank_mask:0xf
  v_and_b32_dpp v215, v48, v5 row_newbcast:7 row_mask:0xf bank_mask:0xf
  s_nop 1
  v_mfma_f32_16x16x32_bf16 v[216:219], v[212:215], v[172:175], v[216:219]
  v_cmp_gt_u32 vcc, 32, v1
  v_mov_b32 v221, s76
  v_mov_b32 v223, s76
  s_mov_b32 exec_lo, s82
  s_mov_b32 exec_hi, s82
  s_nop 2
  v_cndmask_b32 v220, v218, v216, vcc
  v_cndmask_b32 v222, v219, v217, vcc
  buffer_store_dwordx4 v[220:223], v6, s[44:47], s15 offen sc1
  s_mov_b64 exec, -1
  s_cmp_ge_u32 s11, 56
  s_cbranch_scc1 L_xend
  s_cmp_ge_u32 s3, 1
  s_cbranch_scc1 L_xend
  s_mov_b32 s52, s38
  s_mov_b32 s53, s39
  s_mov_b32 s54, 1792
  s_mov_b32 s55, 0x20000
  s_mov_b32 s12, 1
  s_mov_b32 s13, s11
  s_sub_u32 s5, s13, 48
  s_lshr_b32 s6, s5, 1
  s_lshl_b32 s6, s6, 2
  s_and_b32 s5, s5, 1
  s_add_u32 s6, s6, s5
  s_add_u32 s6, s6, 48
  s_cmp_ge_u32 s13, 48
  s_cselect_b32 s13, s6, s13
  s_mul_i32 s6, s12, 540672
  s_lshl_b32 s5, s13, 6
  s_add_u32 s6, s6, s5
  s_add_u32 s6, s6, 2097152
  v_lshrrev_b32 v233, 2, v1
  v_mul_u32_u24 v233, 4224, v233
  v_and_b32 v234, 3, v1
  v_lshl_add_u32 v233, v234, 4, v233
  s_mul_i32 s15, s12, 896
  s_lshr_b32 s5, s13, 4
  s_lshl_b32 s5, s5, 8
  s_add_u32 s15, s15, s5
  s_and_b32 s5, s13, 3
  s_lshl_b32 s5, s5, 6
  s_add_u32 s15, s15, s5
  s_bfe_u32 s5, s13, 0x10002
  s_lshl_b32 s5, s5, 3
  s_add_u32 s15, s15, s5
  s_bfe_u32 s5, s13, 0x10003
  s_lshl_b32 s5, s5, 2
  s_add_u32 s15, s15, s5
  v_lshlrev_b32 v232, 2, v1
  s_mov_b32 s78, 2000
  s_add_u32 s64, s6, 4
  s_add_u32 s65, s6, 156292
  s_add_u32 s66, s6, 312580
Lsp_80:
  s_load_dword s68, s[42:43], s64 glc
  s_load_dword s69, s[42:43], s65 glc
  s_load_dword s70, s[42:43], s66 glc
  s_waitcnt lgkmcnt(0)
  s_mov_b32 s83, 0
  s_cmp_eq_u32 s68, s76
  s_addc_u32 s83, s83, 0
  s_cmp_eq_u32 s69, s76
  s_addc_u32 s83, s83, 0
  s_cmp_eq_u32 s70, s76
  s_addc_u32 s83, s83, 0
  s_cmp_ge_u32 s83, 3
  s_cbranch_scc1 Lspd_81
  s_sleep 2
  s_sub_u32 s78, s78, 1
  s_cmp_lg_u32 s78, 0
  s_cbranch_scc1 Lsp_80
Lspd_81:
  s_mov_b32 s78, 100000
Lpoll_82:
  s_add_u32 s79, s6, 0
  buffer_load_dwordx4 v[80:83], v233, s[44:47], s79 offen sc1
  s_add_u32 s79, s6, 67584
  buffer_load_dwordx4 v[84:87], v233, s[44:47], s79 offen sc1
  s_add_u32 s79, s6, 135168
  buffer_load_dwordx4 v[88:91], v233, s[44:47], s79 offen sc1
  s_add_u32 s79, s6, 202752
  buffer_load_dwordx4 v[92:95], v233, s[44:47], s79 offen sc1
  s_add_u32 s79, s6, 270336
  buffer_load_dwordx4 v[96:99], v233, s[44:47], s79 offen sc1
  s_add_u32 s79, s6, 337920
  buffer_load_dwordx4 v[100:103], v233, s[44:47], s79 offen sc1
  s_add_u32 s79, s6, 405504
  buffer_load_dwordx4 v[104:107], v233, s[44:47], s79 offen sc1
  s_add_u32 s79, s6, 473088
  buffer_load_dwordx4 v[108:111], v233, s[44:47], s79 offen sc1
Lpw_83:
  s_waitcnt vmcnt(0)
  v_bitop3_b32 v228, v81, v83, s76 bitop3:0x7e
  v_bitop3_b32 v229, v85, v87, s76 bitop3:0x7e
  v_bitop3_b32 v89, v89, v91, s76 bitop3:0x7e
  v_bitop3_b32 v93, v93, v95, s76 bitop3:0x7e
  v_bitop3_b32 v97, v97, v99, s76 bitop3:0x7e
  v_bitop3_b32 v101, v101, v103, s76 bitop3:0x7e
  v_bitop3_b32 v105, v105, v107, s76 bitop3:0x7e
  v_bitop3_b32 v109, v109, v111, s76 bitop3:0x7e
  v_or3_b32 v228, v228, v229, v89
  v_or3_b32 v228, v228, v93, v97
  v_or3_b32 v228, v228, v101, v105
  v_or3_b32 v228, v228, v109, v109
  v_cmp_ne_u32 vcc, 0, v228
  s_nop 0
  s_cmp_eq_u64 vcc, 0
  s_nop 1
  s_cbranch_scc1 Lpd_84
  s_sleep 2
  s_sub_u32 s78, s78, 1
  s_cmp_lg_u32 s78, 0
  s_cbranch_scc1 Lpoll_82
Lpd_84:
  v_add_f32 v80, v80, v96
  v_add_f32 v82, v82, v98
  v_add_f32 v84, v84, v100
  v_add_f32 v86, v86, v102
  v_add_f32 v88, v88, v104
  v_add_f32 v90, v90, v106
  v_add_f32 v92, v92, v108
  v_add_f32 v94, v94, v110
  v_add_f32 v80, v80, v88
  v_add_f32 v82, v82, v90
  v_add_f32 v84, v84, v92
  v_add_f32 v86, v86, v94
  v_add_f32 v80, v80, v84
  v_add_f32 v82, v82, v86
  s_nop 0
  v_add_f32_dpp v80, v80, v80 row_ror:8 row_mask:0xf bank_mask:0xf
  v_add_f32_dpp v82, v82, v82 row_ror:8 row_mask:0xf bank_mask:0xf
  s_nop 0
  v_add_f32_dpp v80, v80, v80 row_ror:4 row_mask:0xf bank_mask:0xf
  v_add_f32_dpp v82, v82, v82 row_ror:4 row_mask:0xf bank_mask:0xf
  v_mov_b32 v81, v80
  s_nop 1
  v_permlane32_swap_b32 v80, v81
  v_add_f32 v80, v80, v81
  v_mov_b32 v81, v80
  s_nop 1
  v_permlane16_swap_b32 v80, v81
  v_add_f32 v80, v80, v81
  v_mov_b32 v83, v82
  s_nop 1
  v_permlane32_swap_b32 v82, v83
  v_add_f32 v82, v82, v83
  v_mov_b32 v83, v82
  s_nop 1
  v_permlane16_swap_b32 v82, v83
  v_add_f32 v82, v82, v83
  v_cvt_pk_bf16_f32 v80, v80, v82
  s_mov_b32 exec_lo, 0xf
  s_mov_b32 exec_hi, 0x0
  buffer_store_dword v80, v6, s[52:55], s15 offen
  s_mov_b64 exec, -1
L_xend:
  s_endpgm
L_A:
  s_sub_u32 s11, s2, 256
  s_lshr_b32 s6, s11, 3
  s_add_u32 s6, s6, s11
  s_and_b32 s12, s11, 8
  s_sub_u32 s6, s6, s12
  s_bfe_u32 s9, s6, 0x30001
  s_and_b32 s12, s6, 1
  s_lshr_b32 s6, s11, 7
  s_lshl_b32 s6, s6, 3
  s_and_b32 s10, s11, 7
  s_add_u32 s13, s10, s6
  s_lshl_b32 s10, s12, 4
  s_add_u32 s10, s10, s13
  s_lshl_b32 s14, s9, 22
  s_lshl_b32 s6, s12, 21
  s_add_u32 s14, s14, s6
  s_lshl_b32 s8, s13, 2
  s_add_u32 s8, s8, s3
  s_mul_i32 s8, s8, 20480
  s_add_u32 s8, s8, s14
  s_add_u32 s14, s14, 1310720
  s_lshl_b32 s15, s9, 1
  s_add_u32 s15, s15, s12
  s_lshl_b32 s15, s15, 8
  s_add_u32 s15, s15, 180224
  v_mov_b32 v254, 0
  v_bfe_u32 v8, v1, 2, 2
  v_lshlrev_b32 v8, 9, v8
  v_lshrrev_b32 v10, 4, v1
  v_lshl_add_u32 v8, v10, 6, v8
  v_and_b32 v11, 3, v1
  v_lshl_add_u32 v8, v11, 4, v8
  v_and_b32 v9, 15, v1
  v_lshlrev_b32 v9, 4, v9
  v_lshl_add_u32 v9, v10, 9, v9
  v_and_b32 v208, 1, v1
  v_lshlrev_b32 v208, 4, v208
  v_mov_b32 v209, 0xffff
  v_lshlrev_b32 v208, v208, v209
  v_bfe_u32 v209, v1, 1, 2
  v_cmp_eq_u32 vcc, 0, v209
  s_nop 1
  v_cndmask_b32 v2, 0, v208, vcc
  v_cmp_eq_u32 vcc, 1, v209
  s_nop 1
  v_cndmask_b32 v3, 0, v208, vcc
  v_cmp_eq_u32 vcc, 2, v209
  s_nop 1
  v_cndmask_b32 v4, 0, v208, vcc
  v_cmp_eq_u32 vcc, 3, v209
  s_nop 1
  v_cndmask_b32 v5, 0, v208, vcc
  s_waitcnt lgkmcnt(0)
  s_or_b32 s77, s4, 1
  s_mov_b32 s44, s42
  s_mov_b32 s45, s43
  s_mov_b32 s46, 268435456
  s_mov_b32 s47, 0x20000
  s_mov_b32 s48, s40
  s_mov_b32 s49, s41
  s_mov_b32 s50, 256
  s_mov_b32 s51, 0x20000
  s_mov_b32 s68, s18
  s_mov_b32 s69, s19
  s_mov_b32 s70, 33554432
  s_mov_b32 s71, 0x20000
  s_mov_b32 s72, s20
  s_mov_b32 s73, s21
  s_mov_b32 s74, 33554432
  s_mov_b32 s75, 0x20000
  s_cmp_lt_u32 s11, 128
  s_cbranch_scc1 Lp1j_85
  s_mov_b32 s52, s16
  s_mov_b32 s53, s17
  s_mov_b32 s54, 896
  s_mov_b32 s55, 0x20000
  s_mov_b32 s56, s22
  s_mov_b32 s57, s23
  s_mov_b32 s58, 3670016
  s_mov_b32 s59, 0x20000
  s_and_b32 s13, s11, 127
  s_cmp_ge_u32 s13, 8
  s_cbranch_scc1 Lcz_86
  s_cmp_lg_u32 s3, 3
  s_cbranch_scc1 Lcz_86
  s_lshl_b32 s6, s13, 9
  s_add_u32 s6, s6, 180224
  v_lshlrev_b32 v208, 8, v1
  s_mov_b32 exec_lo, 0x3
  s_mov_b32 exec_hi, 0x0
  buffer_store_dword v254, v208, s[44:47], s6 offen sc1
  s_mov_b64 exec, -1
Lcz_86:
  s_and_b32 s100, s13, 7
  s_lshl_b32 s100, s100, 3
  s_bfe_u32 s6, s13, 0x30003
  s_add_u32 s100, s100, s6
  s_lshr_b32 s101, s13, 6
  s_mul_i32 s96, s101, 224
  s_mul_i32 s6, s3, 56
  s_add_u32 s96, s96, s6
  s_lshl_b32 s97, s96, 1
  s_lshl_b32 s96, s96, 13
  s_lshl_b32 s6, s100, 7
  s_add_u32 s96, s96, s6
  v_lshrrev_b32 v208, 3, v1
  v_mul_u32_u24 v224, 14, v208
  v_and_b32 v224, 0x7c, v224
  v_mul_u32_u24 v225, 57344, v208
  v_and_b32 v209, 7, v1
  v_lshl_add_u32 v225, v209, 4, v225
  buffer_load_dwordx4 v[112:115], v224, s[52:55], s97 offen
  s_add_u32 s79, s96, 0
  buffer_load_dwordx4 v[116:119], v225, s[56:59], s79 offen nt
  s_add_u32 s79, s96, 8192
  buffer_load_dwordx4 v[120:123], v225, s[56:59], s79 offen nt
  s_add_u32 s79, s96, 16384
  buffer_load_dwordx4 v[124:127], v225, s[56:59], s79 offen nt
  s_add_u32 s79, s96, 24576
  buffer_load_dwordx4 v[128:131], v225, s[56:59], s79 offen nt
  s_add_u32 s79, s96, 32768
  buffer_load_dwordx4 v[132:135], v225, s[56:59], s79 offen nt
  s_add_u32 s79, s96, 40960
  buffer_load_dwordx4 v[136:139], v225, s[56:59], s79 offen nt
  s_add_u32 s79, s96, 49152
  buffer_load_dwordx4 v[140:143], v225, s[56:59], s79 offen nt
  s_lshl_b32 s100, s100, 9
  s_lshl_b32 s101, s101, 15
  s_add_u32 s100, s100, s101
  v_bfe_u32 v208, v1, 3, 1
  v_cmp_eq_u32 vcc, 1, v208
  v_mov_b32 v216, 0x01000100
  v_mov_b32 v217, 0x03020302
  v_mov_b32 v218, 0x05040504
  v_cndmask_b32 v226, v216, v217, vcc
  v_cndmask_b32 v227, v217, v218, vcc
  s_lshl_b32 s5, s3, 10
  v_add_u32 v228, s5, v6
  v_and_b32 v211, 3, v1
  v_lshrrev_b32 v229, 5, v1
  v_lshlrev_b32 v229, 11, v229
  v_bfe_u32 v208, v1, 1, 1
  v_lshl_add_u32 v229, v208, 8, v229
  v_bfe_u32 v208, v1, 2, 3
  v_lshl_add_u32 v229, v208, 4, v229
  v_and_b32 v208, 1, v1
  v_lshl_add_u32 v229, v208, 3, v229
  s_waitcnt vmcnt(3)
  buffer_load_dword v255, v254, s[48:51], 0 offen sc1
  s_waitcnt vmcnt(0)
  s_mov_b32 s78, 100000
Lge_87:
  v_readfirstlane_b32 s76, v255
  s_nop 0
  s_cmp_lg_u32 s76, 0
  s_nop 1
  s_cbranch_scc1 Lged_88
  buffer_load_dword v255, v254, s[48:51], 0 offen sc1
  s_waitcnt vmcnt(0)
  s_sub_u32 s78, s78, 1
  s_cmp_lg_u32 s78, 0
  s_cbranch_scc1 Lge_87
Lged_88:
  s_setprio 3
  v_perm_b32 v216, v112, v112, v226
  v_and_b32 v208, v216, v2
  v_and_b32 v209, v216, v3
  v_and_b32 v210, v216, v4
  v_and_b32 v211, v216, v5
  s_nop 1
  v_mfma_f32_16x16x32_bf16 v[220:223], v[208:211], v[116:119], 0
  v_perm_b32 v216, v113, v112, v227
  v_and_b32 v212, v216, v2
  v_and_b32 v213, v216, v3
  v_and_b32 v214, v216, v4
  v_and_b32 v215, v216, v5
  s_nop 1
  v_mfma_f32_16x16x32_bf16 v[220:223], v[212:215], v[120:123], v[220:223]
  v_perm_b32 v216, v113, v113, v226
  v_and_b32 v208, v216, v2
  v_and_b32 v209, v216, v3
  v_and_b32 v210, v216, v4
  v_and_b32 v211, v216, v5
  s_nop 1
  v_mfma_f32_16x16x32_bf16 v[220:223], v[208:211], v[124:127], v[220:223]
  v_perm_b32 v216, v114, v113, v227
  v_and_b32 v212, v216, v2
  v_and_b32 v213, v216, v3
  v_and_b32 v214, v216, v4
  v_and_b32 v215, v216, v5
  s_nop 1
  v_mfma_f32_16x16x32_bf16 v[220:223], v[212:215], v[128:131], v[220:223]
  v_perm_b32 v216, v114, v114, v226
  v_and_b32 v208, v216, v2
  v_and_b32 v209, v216, v3
  v_and_b32 v210, v216, v4
  v_and_b32 v211, v216, v5
  s_nop 1
  v_mfma_f32_16x16x32_bf16 v[220:223], v[208:211], v[132:135], v[220:223]
  v_perm_b32 v216, v115, v114, v227
  v_and_b32 v212, v216, v2
  v_and_b32 v213, v216, v3
  v_and_b32 v214, v216, v4
  v_and_b32 v215, v216, v5
  s_nop 1
  v_mfma_f32_16x16x32_bf16 v[220:223], v[212:215], v[136:139], v[220:223]
  v_perm_b32 v216, v115, v115, v226
  v_and_b32 v208, v216, v2
  v_and_b32 v209, v216, v3
  v_and_b32 v210, v216, v4
  v_and_b32 v211, v216, v5
  s_nop 1
  v_mfma_f32_16x16x32_bf16 v[220:223], v[208:211], v[140:143], v[220:223]
  s_nop 7
  ds_write_b128 v228, v[220:223] offset:4096
  s_waitcnt lgkmcnt(0)
  s_barrier
  s_cmp_lg_u32 s3, 3
  s_cbranch_scc1 Lred_89
  ds_read_b64 v[208:209], v229 offset:4096
  ds_read_b64 v[210:211], v229 offset:4736
  ds_read_b64 v[212:213], v229 offset:5120
  ds_read_b64 v[214:215], v229 offset:5760
  s_add_u32 s5, s100, 65536
  v_mov_b32 v217, s76
  v_mov_b32 v219, s76
  s_waitcnt lgkmcnt(0)
  v_pk_add_f32 v[208:209], v[208:209], v[210:211]
  v_pk_add_f32 v[212:213], v[212:213], v[214:215]
  v_pk_add_f32 v[208:209], v[208:209], v[212:213]
  v_mov_b64 v[210:211], v[208:209]
  s_nop 1
  v_permlane32_swap_b32 v208, v210
  v_permlane32_swap_b32 v209, v211
  v_add_f32 v216, v208, v210
  v_add_f32 v218, v209, v211
  s_mov_b32 exec_lo, 0xffffffff
  s_mov_b32 exec_hi, 0x0
  buffer_store_dwordx4 v[216:219], v6, s[44:47], s5 offen sc1
  s_mov_b64 exec, -1
Lred_89:
  s_setprio 0
Lp1j_85:
  v_bfe_u32 v12, v1, 3, 1
  v_lshlrev_b32 v12, 9, v12
  v_lshl_add_u32 v12, v10, 6, v12
  v_lshl_add_u32 v12, v11, 4, v12
  s_cmp_ge_u32 s11, 128
  s_cbranch_scc1 Lpc_90
  s_waitcnt vmcnt(0)
Lpc_90:
  s_add_u32 s79, s8, 0
  s_waitcnt vmcnt(3)
  buffer_load_dwordx4 v[16:19], v8, s[68:71], s79 offen offset:0 nt
  s_cmp_ge_u32 s11, 128
  s_cbranch_scc1 Lpc_91
  s_waitcnt vmcnt(0)
Lpc_91:
  s_add_u32 s79, s8, 0
  s_waitcnt vmcnt(3)
  buffer_load_dwordx4 v[20:23], v8, s[68:71], s79 offen offset:256 nt
  s_cmp_ge_u32 s11, 128
  s_cbranch_scc1 Lpc_92
  s_waitcnt vmcnt(0)
Lpc_92:
  s_add_u32 s79, s8, 0
  s_waitcnt vmcnt(3)
  buffer_load_dwordx4 v[24:27], v8, s[68:71], s79 offen offset:2048 nt
  s_cmp_ge_u32 s11, 128
  s_cbranch_scc1 Lpc_93
  s_waitcnt vmcnt(0)
Lpc_93:
  s_add_u32 s79, s8, 0
  s_waitcnt vmcnt(3)
  buffer_load_dwordx4 v[28:31], v8, s[68:71], s79 offen offset:2304 nt
  s_cmp_lt_u32 s11, 128
  s_cbranch_scc1 Lpc_94
  s_waitcnt vmcnt(3)
Lpc_94:
  s_add_u32 s79, s8, 4096
  s_waitcnt vmcnt(7)
  buffer_load_dwordx4 v[32:35], v8, s[68:71], s79 offen offset:0 nt
  s_cmp_lt_u32 s11, 128
  s_cbranch_scc1 Lpc_95
  s_waitcnt vmcnt(3)
Lpc_95:
  s_add_u32 s79, s8, 4096
  s_waitcnt vmcnt(7)
  buffer_load_dwordx4 v[36:39], v8, s[68:71], s79 offen offset:256 nt
  s_cmp_lt_u32 s11, 128
  s_cbranch_scc1 Lpc_96
  s_waitcnt vmcnt(3)
Lpc_96:
  s_add_u32 s79, s8, 4096
  s_waitcnt vmcnt(7)
  buffer_load_dwordx4 v[40:43], v8, s[68:71], s79 offen offset:2048 nt
  s_cmp_lt_u32 s11, 128
  s_cbranch_scc1 Lpc_97
  s_waitcnt vmcnt(3)
Lpc_97:
  s_add_u32 s79, s8, 4096
  s_waitcnt vmcnt(7)
  buffer_load_dwordx4 v[44:47], v8, s[68:71], s79 offen offset:2304 nt
  s_cmp_lt_u32 s11, 128
  s_cbranch_scc1 Lpc_98
  s_waitcnt vmcnt(3)
Lpc_98:
  s_add_u32 s79, s8, 8192
  s_waitcnt vmcnt(7)
  buffer_load_dwordx4 v[48:51], v8, s[68:71], s79 offen offset:0 nt
  s_cmp_lt_u32 s11, 128
  s_cbranch_scc1 Lpc_99
  s_waitcnt vmcnt(3)
Lpc_99:
  s_add_u32 s79, s8, 8192
  s_waitcnt vmcnt(7)
  buffer_load_dwordx4 v[52:55], v8, s[68:71], s79 offen offset:256 nt
  s_cmp_lt_u32 s11, 128
  s_cbranch_scc1 Lpc_100
  s_waitcnt vmcnt(3)
Lpc_100:
  s_add_u32 s79, s8, 8192
  s_waitcnt vmcnt(7)
  buffer_load_dwordx4 v[56:59], v8, s[68:71], s79 offen offset:2048 nt
  s_cmp_lt_u32 s11, 128
  s_cbranch_scc1 Lpc_101
  s_waitcnt vmcnt(3)
Lpc_101:
  s_add_u32 s79, s8, 8192
  s_waitcnt vmcnt(7)
  buffer_load_dwordx4 v[60:63], v8, s[68:71], s79 offen offset:2304 nt
  s_cmp_lt_u32 s11, 128
  s_cbranch_scc1 Lpc_102
  s_waitcnt vmcnt(3)
Lpc_102:
  s_add_u32 s79, s8, 12288
  s_waitcnt vmcnt(7)
  buffer_load_dwordx4 v[64:67], v8, s[68:71], s79 offen offset:0 nt
  buffer_load_dword v255, v254, s[48:51], 0 offen sc1
  s_cmp_lt_u32 s11, 128
  s_cbranch_scc1 Lpc_103
  s_waitcnt vmcnt(3)
Lpc_103:
  s_add_u32 s79, s8, 12288
  s_waitcnt vmcnt(7)
  buffer_load_dwordx4 v[68:71], v8, s[68:71], s79 offen offset:256 nt
  s_cmp_lt_u32 s11, 128
  s_cbranch_scc1 Lpc_104
  s_waitcnt vmcnt(3)
Lpc_104:
  s_add_u32 s79, s8, 12288
  s_waitcnt vmcnt(7)
  buffer_load_dwordx4 v[72:75], v8, s[68:71], s79 offen offset:2048 nt
  s_cmp_lt_u32 s11, 128
  s_cbranch_scc1 Lpc_105
  s_waitcnt vmcnt(3)
Lpc_105:
  s_add_u32 s79, s8, 12288
  s_waitcnt vmcnt(7)
  buffer_load_dwordx4 v[76:79], v8, s[68:71], s79 offen offset:2304 nt
  s_add_u32 s79, s8, 16384
  s_waitcnt vmcnt(7)
  buffer_load_dwordx4 v[80:83], v8, s[68:71], s79 offen offset:0 nt
  s_add_u32 s79, s8, 16384
  s_waitcnt vmcnt(7)
  buffer_load_dwordx4 v[84:87], v8, s[68:71], s79 offen offset:256 nt
  s_add_u32 s79, s8, 16384
  s_waitcnt vmcnt(7)
  buffer_load_dwordx4 v[88:91], v8, s[68:71], s79 offen offset:2048 nt
  s_add_u32 s79, s8, 16384
  s_waitcnt vmcnt(7)
  buffer_load_dwordx4 v[92:95], v8, s[68:71], s79 offen offset:2304 nt
  s_waitcnt vmcnt(7)
  s_mov_b32 s78, 100000
Lge_106:
  v_readfirstlane_b32 s76, v255
  s_nop 0
  s_cmp_lg_u32 s76, 0
  s_nop 1
  s_cbranch_scc1 Lged_107
  buffer_load_dword v255, v254, s[48:51], 0 offen sc1
  s_waitcnt vmcnt(0)
  s_sub_u32 s78, s78, 1
  s_cmp_lg_u32 s78, 0
  s_cbranch_scc1 Lge_106
Lged_107:
  s_add_u32 s79, s8, 0
  s_waitcnt vmcnt(7)
  buffer_load_dwordx4 v[112:115], v9, s[72:75], s79 offen offset:0 nt
  s_add_u32 s79, s8, 0
  s_waitcnt vmcnt(7)
  buffer_load_dwordx4 v[116:119], v9, s[72:75], s79 offen offset:256 nt
  s_add_u32 s79, s8, 0
  s_waitcnt vmcnt(7)
  buffer_load_dwordx4 v[120:123], v9, s[72:75], s79 offen offset:2048 nt
  s_add_u32 s79, s8, 0
  s_waitcnt vmcnt(7)
  buffer_load_dwordx4 v[124:127], v9, s[72:75], s79 offen offset:2304 nt
  s_lshl_b32 s6, s9, 12
  s_lshl_b32 s5, s3, 10
  s_add_u32 s6, s6, s5
  s_add_u32 s6, s6, 65536
  v_lshlrev_b32 v228, 2, v0
  s_add_u32 s7, s6, 0x8000
  buffer_load_dwordx4 v[208:211], v6, s[44:47], s6 offen offset:0 sc1
  buffer_load_dwordx4 v[212:215], v6, s[44:47], s7 offen offset:0 sc1
  s_add_u32 s79, s8, 4096
  s_waitcnt vmcnt(7)
  buffer_load_dwordx4 v[128:131], v9, s[72:75], s79 offen offset:0 nt
  s_add_u32 s79, s8, 4096
  s_waitcnt vmcnt(7)
  buffer_load_dwordx4 v[132:135], v9, s[72:75], s79 offen offset:256 nt
  s_add_u32 s79, s8, 4096
  s_waitcnt vmcnt(7)
  buffer_load_dwordx4 v[136:139], v9, s[72:75], s79 offen offset:2048 nt
  s_add_u32 s79, s8, 4096
  s_waitcnt vmcnt(7)
  buffer_load_dwordx4 v[140:143], v9, s[72:75], s79 offen offset:2304 nt
  s_add_u32 s79, s8, 8192
  s_waitcnt vmcnt(7)
  buffer_load_dwordx4 v[144:147], v9, s[72:75], s79 offen offset:0 nt
  s_add_u32 s79, s8, 8192
  s_waitcnt vmcnt(7)
  buffer_load_dwordx4 v[148:151], v9, s[72:75], s79 offen offset:256 nt
  s_add_u32 s79, s8, 8192
  s_waitcnt vmcnt(7)
  buffer_load_dwordx4 v[152:155], v9, s[72:75], s79 offen offset:2048 nt
  s_add_u32 s79, s8, 8192
  s_waitcnt vmcnt(7)
  buffer_load_dwordx4 v[156:159], v9, s[72:75], s79 offen offset:2304 nt
  s_waitcnt vmcnt(8)
  v_bitop3_b32 v216, v209, v211, s76 bitop3:0x7e
  v_bitop3_b32 v217, v213, v215, s76 bitop3:0x7e
  v_or3_b32 v216, v216, v217, v217
  v_cmp_ne_u32 vcc, 0, v216
  s_nop 0
  s_cmp_eq_u64 vcc, 0
  s_nop 1
  s_cbranch_scc1 Lgq_108
  s_mov_b32 s78, 100000
Lpoll_109:
  buffer_load_dwordx4 v[208:211], v6, s[44:47], s6 offen offset:0 sc1
  buffer_load_dwordx4 v[212:215], v6, s[44:47], s7 offen offset:0 sc1
Lpw_110:
  s_waitcnt vmcnt(0)
  v_bitop3_b32 v216, v209, v211, s76 bitop3:0x7e
  v_bitop3_b32 v217, v213, v215, s76 bitop3:0x7e
  v_or3_b32 v216, v216, v217, v217
  v_cmp_ne_u32 vcc, 0, v216
  s_nop 0
  s_cmp_eq_u64 vcc, 0
  s_nop 1
  s_cbranch_scc1 Lpd_111
  s_sleep 6
  s_sub_u32 s78, s78, 1
  s_cmp_lg_u32 s78, 0
  s_cbranch_scc1 Lpoll_109
Lpd_111:
Lgq_108:
  v_add_f32 v208, v208, v212
  v_add_f32 v210, v210, v214
  v_cvt_pk_bf16_f32 v208, v208, v210
  ds_write_b32 v228, v208 offset:0
  s_waitcnt lgkmcnt(0)
  s_barrier
  ds_read_b128 v[208:211], v12
  ds_read_b128 v[212:215], v12 offset:256
  s_mov_b32 s13, 0x3db8aa3b
  s_waitcnt vmcnt(8) lgkmcnt(0)
  v_mfma_f32_16x16x32_bf16 v[224:227], v[16:19], v[208:211], 0
  v_mfma_f32_16x16x32_bf16 v[224:227], v[20:23], v[212:215], v[224:227]
  v_mfma_f32_16x16x32_bf16 v[228:231], v[24:27], v[208:211], 0
  v_mfma_f32_16x16x32_bf16 v[228:231], v[28:31], v[212:215], v[228:231]
  v_mfma_f32_16x16x32_bf16 v[16:19], v[32:35], v[208:211], 0
  v_mfma_f32_16x16x32_bf16 v[16:19], v[36:39], v[212:215], v[16:19]
  v_mfma_f32_16x16x32_bf16 v[24:27], v[40:43], v[208:211], 0
  v_mfma_f32_16x16x32_bf16 v[24:27], v[44:47], v[212:215], v[24:27]
  v_mfma_f32_16x16x32_bf16 v[32:35], v[48:51], v[208:211], 0
  v_mfma_f32_16x16x32_bf16 v[32:35], v[52:55], v[212:215], v[32:35]
  v_mfma_f32_16x16x32_bf16 v[40:43], v[56:59], v[208:211], 0
  v_mfma_f32_16x16x32_bf16 v[40:43], v[60:63], v[212:215], v[40:43]
  s_add_u32 s79, s8, 12288
  s_waitcnt vmcnt(7)
  buffer_load_dwordx4 v[160:163], v9, s[72:75], s79 offen offset:0 nt
  v_mfma_f32_16x16x32_bf16 v[48:51], v[64:67], v[208:211], 0
  v_mfma_f32_16x16x32_bf16 v[48:51], v[68:71], v[212:215], v[48:51]
  v_mfma_f32_16x16x32_bf16 v[56:59], v[72:75], v[208:211], 0
  v_mfma_f32_16x16x32_bf16 v[56:59], v[76:79], v[212:215], v[56:59]
  v_mfma_f32_16x16x32_bf16 v[64:67], v[80:83], v[208:211], 0
  v_mfma_f32_16x16x32_bf16 v[64:67], v[84:87], v[212:215], v[64:67]
  v_mfma_f32_16x16x32_bf16 v[72:75], v[88:91], v[208:211], 0
  v_mfma_f32_16x16x32_bf16 v[72:75], v[92:95], v[212:215], v[72:75]
  v_mov_b32_dpp v232, v224 quad_perm:[0,0,0,0] row_mask:0xf bank_mask:0xf
  v_mov_b32_dpp v233, v228 quad_perm:[0,0,0,0] row_mask:0xf bank_mask:0xf
  v_mov_b32_dpp v234, v16 quad_perm:[0,0,0,0] row_mask:0xf bank_mask:0xf
  v_mov_b32_dpp v235, v24 quad_perm:[0,0,0,0] row_mask:0xf bank_mask:0xf
  v_mov_b32_dpp v236, v32 quad_perm:[0,0,0,0] row_mask:0xf bank_mask:0xf
  v_mov_b32_dpp v237, v40 quad_perm:[0,0,0,0] row_mask:0xf bank_mask:0xf
  v_mov_b32_dpp v238, v48 quad_perm:[0,0,0,0] row_mask:0xf bank_mask:0xf
  v_mov_b32_dpp v239, v56 quad_perm:[0,0,0,0] row_mask:0xf bank_mask:0xf
  v_mov_b32_dpp v240, v64 quad_perm:[0,0,0,0] row_mask:0xf bank_mask:0xf
  v_mov_b32_dpp v241, v72 quad_perm:[0,0,0,0] row_mask:0xf bank_mask:0xf
  v_add_f32_dpp v232, v225, v232 quad_perm:[1,1,1,1] row_mask:0xf bank_mask:0xf
  v_add_f32_dpp v233, v229, v233 quad_perm:[1,1,1,1] row_mask:0xf bank_mask:0xf
  v_add_f32_dpp v234, v17, v234 quad_perm:[1,1,1,1] row_mask:0xf bank_mask:0xf
  v_add_f32_dpp v235, v25, v235 quad_perm:[1,1,1,1] row_mask:0xf bank_mask:0xf
  v_add_f32_dpp v236, v33, v236 quad_perm:[1,1,1,1] row_mask:0xf bank_mask:0xf
  v_add_f32_dpp v237, v41, v237 quad_perm:[1,1,1,1] row_mask:0xf bank_mask:0xf
  v_add_f32_dpp v238, v49, v238 quad_perm:[1,1,1,1] row_mask:0xf bank_mask:0xf
  v_add_f32_dpp v239, v57, v239 quad_perm:[1,1,1,1] row_mask:0xf bank_mask:0xf
  v_add_f32_dpp v240, v65, v240 quad_perm:[1,1,1,1] row_mask:0xf bank_mask:0xf
  v_add_f32_dpp v241, v73, v241 quad_perm:[1,1,1,1] row_mask:0xf bank_mask:0xf
  v_add_f32_dpp v232, v226, v232 quad_perm:[2,2,2,2] row_mask:0xf bank_mask:0xf
  v_add_f32_dpp v233, v230, v233 quad_perm:[2,2,2,2] row_mask:0xf bank_mask:0xf
  v_add_f32_dpp v234, v18, v234 quad_perm:[2,2,2,2] row_mask:0xf bank_mask:0xf
  v_add_f32_dpp v235, v26, v235 quad_perm:[2,2,2,2] row_mask:0xf bank_mask:0xf
  v_add_f32_dpp v236, v34, v236 quad_perm:[2,2,2,2] row_mask:0xf bank_mask:0xf
  v_add_f32_dpp v237, v42, v237 quad_perm:[2,2,2,2] row_mask:0xf bank_mask:0xf
  v_add_f32_dpp v238, v50, v238 quad_perm:[2,2,2,2] row_mask:0xf bank_mask:0xf
  v_add_f32_dpp v239, v58, v239 quad_perm:[2,2,2,2] row_mask:0xf bank_mask:0xf
  v_add_f32_dpp v240, v66, v240 quad_perm:[2,2,2,2] row_mask:0xf bank_mask:0xf
  v_add_f32_dpp v241, v74, v241 quad_perm:[2,2,2,2] row_mask:0xf bank_mask:0xf
  v_add_f32_dpp v232, v227, v232 quad_perm:[3,3,3,3] row_mask:0xf bank_mask:0xf
  v_add_f32_dpp v233, v231, v233 quad_perm:[3,3,3,3] row_mask:0xf bank_mask:0xf
  v_add_f32_dpp v234, v19, v234 quad_perm:[3,3,3,3] row_mask:0xf bank_mask:0xf
  v_add_f32_dpp v235, v27, v235 quad_perm:[3,3,3,3] row_mask:0xf bank_mask:0xf
  v_add_f32_dpp v236, v35, v236 quad_perm:[3,3,3,3] row_mask:0xf bank_mask:0xf
  v_add_f32_dpp v237, v43, v237 quad_perm:[3,3,3,3] row_mask:0xf bank_mask:0xf
  v_add_f32_dpp v238, v51, v238 quad_perm:[3,3,3,3] row_mask:0xf bank_mask:0xf
  v_add_f32_dpp v239, v59, v239 quad_perm:[3,3,3,3] row_mask:0xf bank_mask:0xf
  v_add_f32_dpp v240, v67, v240 quad_perm:[3,3,3,3] row_mask:0xf bank_mask:0xf
  v_add_f32_dpp v241, v75, v241 quad_perm:[3,3,3,3] row_mask:0xf bank_mask:0xf
  s_add_u32 s79, s8, 12288
  s_waitcnt vmcnt(7)
  buffer_load_dwordx4 v[164:167], v9, s[72:75], s79 offen offset:256 nt
  v_cvt_pk_bf16_f32 v224, v232, v233
  v_cvt_pk_bf16_f32 v225, v234, v235
  v_cvt_pk_bf16_f32 v226, v236, v237
  v_cvt_pk_bf16_f32 v227, v238, v239
  v_cvt_pk_bf16_f32 v228, v240, v241
  v_lshlrev_b32 v232, 16, v224
  v_and_b32 v233, 0xffff0000, v224
  v_lshlrev_b32 v234, 16, v225
  v_and_b32 v235, 0xffff0000, v225
  v_lshlrev_b32 v236, 16, v226
  v_and_b32 v237, 0xffff0000, v226
  v_lshlrev_b32 v238, 16, v227
  v_and_b32 v239, 0xffff0000, v227
  v_lshlrev_b32 v240, 16, v228
  v_and_b32 v241, 0xffff0000, v228
  v_max3_f32 v244, v232, v233, v234
  v_max3_f32 v244, v244, v235, v236
  v_max3_f32 v244, v244, v237, v238
  v_max3_f32 v244, v244, v239, v240
  v_max3_f32 v244, v244, v241, v241
  v_mov_b32 v249, v244
  s_nop 1
  v_permlane32_swap_b32 v244, v249
  v_max_f32 v244, v244, v249
  v_mov_b32 v249, v244
  s_nop 1
  v_permlane16_swap_b32 v244, v249
  v_max_f32 v244, v244, v249
  v_mul_f32 v244, s13, v244
  v_fma_f32 v232, v232, s13, -v244
  v_fma_f32 v233, v233, s13, -v244
  v_fma_f32 v234, v234, s13, -v244
  v_fma_f32 v235, v235, s13, -v244
  v_fma_f32 v236, v236, s13, -v244
  v_fma_f32 v237, v237, s13, -v244
  v_fma_f32 v238, v238, s13, -v244
  v_fma_f32 v239, v239, s13, -v244
  v_fma_f32 v240, v240, s13, -v244
  v_fma_f32 v241, v241, s13, -v244
  s_add_u32 s79, s8, 12288
  s_waitcnt vmcnt(7)
  buffer_load_dwordx4 v[168:171], v9, s[72:75], s79 offen offset:2048 nt
  v_exp_f32 v232, v232
  v_exp_f32 v233, v233
  v_exp_f32 v234, v234
  v_exp_f32 v235, v235
  v_exp_f32 v236, v236
  v_exp_f32 v237, v237
  v_exp_f32 v238, v238
  v_exp_f32 v239, v239
  v_exp_f32 v240, v240
  v_exp_f32 v241, v241
  v_add_f32 v245, v232, v233
  v_add_f32 v245, v245, v234
  v_add_f32 v245, v245, v235
  v_add_f32 v245, v245, v236
  v_add_f32 v245, v245, v237
  v_add_f32 v245, v245, v238
  v_add_f32 v245, v245, v239
  v_add_f32 v245, v245, v240
  v_add_f32 v245, v245, v241
  v_cvt_pk_bf16_f32 v232, v232, v232
  v_cvt_pk_bf16_f32 v233, v233, v233
  v_cvt_pk_bf16_f32 v234, v234, v234
  v_cvt_pk_bf16_f32 v235, v235, v235
  v_cvt_pk_bf16_f32 v236, v236, v236
  v_cvt_pk_bf16_f32 v237, v237, v237
  v_cvt_pk_bf16_f32 v238, v238, v238
  v_cvt_pk_bf16_f32 v239, v239, v239
  v_cvt_pk_bf16_f32 v240, v240, v240
  v_cvt_pk_bf16_f32 v241, v241, v241
  s_add_u32 s79, s8, 12288
  s_waitcnt vmcnt(7)
  buffer_load_dwordx4 v[172:175], v9, s[72:75], s79 offen offset:2304 nt
  v_and_b32 v224, v232, v2
  v_and_b32 v225, v232, v3
  v_and_b32 v226, v232, v4
  v_and_b32 v227, v232, v5
  s_nop 1
  v_mfma_f32_16x16x32_bf16 v[216:219], v[224:227], v[112:115], 0
  v_mfma_f32_16x16x32_bf16 v[220:223], v[224:227], v[116:119], 0
  v_and_b32 v228, v233, v2
  v_and_b32 v229, v233, v3
  v_and_b32 v230, v233, v4
  v_and_b32 v231, v233, v5
  s_nop 1
  v_mfma_f32_16x16x32_bf16 v[216:219], v[228:231], v[120:123], v[216:219]
  v_mfma_f32_16x16x32_bf16 v[220:223], v[228:231], v[124:127], v[220:223]
  v_and_b32 v224, v234, v2
  v_and_b32 v225, v234, v3
  v_and_b32 v226, v234, v4
  v_and_b32 v227, v234, v5
  s_nop 1
  v_mfma_f32_16x16x32_bf16 v[216:219], v[224:227], v[128:131], v[216:219]
  v_mfma_f32_16x16x32_bf16 v[220:223], v[224:227], v[132:135], v[220:223]
  v_and_b32 v228, v235, v2
  v_and_b32 v229, v235, v3
  v_and_b32 v230, v235, v4
  v_and_b32 v231, v235, v5
  s_nop 1
  v_mfma_f32_16x16x32_bf16 v[216:219], v[228:231], v[136:139], v[216:219]
  v_mfma_f32_16x16x32_bf16 v[220:223], v[228:231], v[140:143], v[220:223]
  s_add_u32 s79, s8, 16384
  s_waitcnt vmcnt(7)
  buffer_load_dwordx4 v[176:179], v9, s[72:75], s79 offen offset:0 nt
  s_mov_b32 s83, 1
  s_atomic_add s83, s[42:43], s15 glc
  s_add_u32 s79, s8, 16384
  s_waitcnt vmcnt(7)
  buffer_load_dwordx4 v[180:183], v9, s[72:75], s79 offen offset:256 nt
  v_and_b32 v224, v236, v2
  v_and_b32 v225, v236, v3
  v_and_b32 v226, v236, v4
  v_and_b32 v227, v236, v5
  s_nop 1
  v_mfma_f32_16x16x32_bf16 v[216:219], v[224:227], v[144:147], v[216:219]
  v_mfma_f32_16x16x32_bf16 v[220:223], v[224:227], v[148:151], v[220:223]
  s_add_u32 s79, s8, 16384
  s_waitcnt vmcnt(7)
  buffer_load_dwordx4 v[184:187], v9, s[72:75], s79 offen offset:2048 nt
  s_add_u32 s79, s8, 16384
  s_waitcnt vmcnt(7)
  buffer_load_dwordx4 v[188:191], v9, s[72:75], s79 offen offset:2304 nt
  v_and_b32 v228, v237, v2
  v_and_b32 v229, v237, v3
  v_and_b32 v230, v237, v4
  v_and_b32 v231, v237, v5
  s_nop 1
  v_mfma_f32_16x16x32_bf16 v[216:219], v[228:231], v[152:155], v[216:219]
  v_mfma_f32_16x16x32_bf16 v[220:223], v[228:231], v[156:159], v[220:223]
  v_bfe_u32 v83, v0, 6, 1
  v_lshlrev_b32 v83, 10, v83
  v_bfe_u32 v81, v0, 7, 1
  v_lshl_add_u32 v83, v81, 9, v83
  v_bfe_u32 v81, v0, 1, 1
  v_lshl_add_u32 v83, v81, 8, v83
  v_bfe_u32 v81, v0, 2, 4
  v_lshl_add_u32 v83, v81, 4, v83
  v_and_b32 v81, 1, v0
  v_lshl_add_u32 v83, v81, 3, v83
  v_bfe_u32 v82, v0, 4, 4
  v_mul_u32_u24 v82, 8320, v82
  v_and_b32 v80, 15, v0
  v_lshl_add_u32 v82, v80, 4, v82
  s_mul_i32 s12, s9, 133120
  s_lshl_b32 s6, s10, 8
  s_add_u32 s12, s12, s6
  s_add_u32 s12, s12, 524288
  s_lshl_b32 s5, s3, 11
  v_add_u32 v12, s5, v6
  v_bfe_u32 v14, v1, 3, 1
  v_lshlrev_b32 v14, 5, v14
  s_lshl_b32 s5, s3, 3
  v_add_u32 v15, s5, v14
  v_lshrrev_b32 v13, 7, v0
  v_lshlrev_b32 v13, 5, v13
  s_lshl_b32 s10, s10, 7
  s_lshl_b32 s5, s9, 12
  s_add_u32 s10, s10, s5
  s_lshr_b32 s5, s3, 1
  s_lshl_b32 s5, s5, 4
  s_add_u32 s10, s10, s5
  s_add_u32 s10, s10, 229376
  v_mov_b32 v101, s76
  v_mov_b32 v103, s76
  v_mov_b32 v105, s76
  v_mov_b32 v107, s76
  s_mov_b32 s60, s24
  s_mov_b32 s61, s25
  s_mov_b32 s62, 3670016
  s_mov_b32 s63, 0x20000
  s_and_b32 s97, s11, 127
  s_mul_i32 s96, s97, 28672
  v_bfe_u32 v108, v1, 4, 1
  v_lshlrev_b32 v108, 4, v108
  v_lshrrev_b32 v109, 5, v1
  v_add_u32 v108, v108, v109
  v_mul_u32_u24 v108, 896, v108
  v_and_b32 v109, 15, v1
  v_lshl_add_u32 v108, v109, 4, v108
  s_lshl_b32 s5, s3, 8
  s_add_u32 s96, s96, s5
  s_cmp_eq_u32 s3, 3
  s_cselect_b32 s82, 0x00ff00ff, -1
  s_cmp_ge_u32 s11, 128
  s_cselect_b32 s5, 0x4000000, 0
  v_add_u32 v108, s5, v108
  s_waitcnt lgkmcnt(0)
  s_mov_b32 s5, s83
  s_cmp_ge_u32 s5, 192
  s_cbranch_scc1 Ln0_113
  s_lshl_b32 s5, s5, 12
  s_add_u32 s79, s14, s5
  s_waitcnt vmcnt(8)
  buffer_load_dwordx4 v[16:19], v8, s[68:71], s79 offen offset:0 nt
  s_waitcnt vmcnt(8)
  buffer_load_dwordx4 v[20:23], v8, s[68:71], s79 offen offset:256 nt
  s_waitcnt vmcnt(8)
  buffer_load_dwordx4 v[24:27], v8, s[68:71], s79 offen offset:2048 nt
  s_waitcnt vmcnt(8)
  buffer_load_dwordx4 v[28:31], v8, s[68:71], s79 offen offset:2304 nt
  s_waitcnt vmcnt(8)
  buffer_load_dwordx4 v[32:35], v9, s[72:75], s79 offen offset:0 nt
  s_waitcnt vmcnt(8)
  buffer_load_dwordx4 v[36:39], v9, s[72:75], s79 offen offset:256 nt
  s_mov_b32 s83, 1
  s_atomic_add s83, s[42:43], s15 glc
  s_waitcnt vmcnt(8)
  buffer_load_dwordx4 v[40:43], v9, s[72:75], s79 offen offset:2048 nt
  s_waitcnt vmcnt(8)
  buffer_load_dwordx4 v[44:47], v9, s[72:75], s79 offen offset:2304 nt
  s_waitcnt vmcnt(8)
  v_and_b32 v224, v238, v2
  v_and_b32 v225, v238, v3
  v_and_b32 v226, v238, v4
  v_and_b32 v227, v238, v5
  s_nop 1
  v_mfma_f32_16x16x32_bf16 v[216:219], v[224:227], v[160:163], v[216:219]
  v_mfma_f32_16x16x32_bf16 v[220:223], v[224:227], v[164:167], v[220:223]
  v_and_b32 v228, v239, v2
  v_and_b32 v229, v239, v3
  v_and_b32 v230, v239, v4
  v_and_b32 v231, v239, v5
  s_nop 1
  v_mfma_f32_16x16x32_bf16 v[216:219], v[228:231], v[168:171], v[216:219]
  v_mfma_f32_16x16x32_bf16 v[220:223], v[228:231], v[172:175], v[220:223]
  v_and_b32 v224, v240, v2
  v_and_b32 v225, v240, v3
  v_and_b32 v226, v240, v4
  v_and_b32 v227, v240, v5
  s_nop 1
  v_mfma_f32_16x16x32_bf16 v[216:219], v[224:227], v[176:179], v[216:219]
  v_mfma_f32_16x16x32_bf16 v[220:223], v[224:227], v[180:183], v[220:223]
  v_and_b32 v228, v241, v2
  v_and_b32 v229, v241, v3
  v_and_b32 v230, v241, v4
  v_and_b32 v231, v241, v5
  s_nop 1
  v_mfma_f32_16x16x32_bf16 v[216:219], v[228:231], v[184:187], v[216:219]
  v_mfma_f32_16x16x32_bf16 v[220:223], v[228:231], v[188:191], v[220:223]
Ld0_114:
  s_waitcnt lgkmcnt(0)
  s_mov_b32 s5, s83
  s_cmp_ge_u32 s5, 192
  s_nop 3
  s_cbranch_scc1 Lf0_115
  s_lshl_b32 s5, s5, 12
  s_add_u32 s79, s14, s5
  s_waitcnt vmcnt(8)
  buffer_load_dwordx4 v[48:51], v8, s[68:71], s79 offen offset:0 nt
  s_waitcnt vmcnt(8)
  buffer_load_dwordx4 v[52:55], v8, s[68:71], s79 offen offset:256 nt
  s_waitcnt vmcnt(8)
  buffer_load_dwordx4 v[56:59], v8, s[68:71], s79 offen offset:2048 nt
  s_waitcnt vmcnt(8)
  buffer_load_dwordx4 v[60:63], v8, s[68:71], s79 offen offset:2304 nt
  s_waitcnt vmcnt(8)
  buffer_load_dwordx4 v[64:67], v9, s[72:75], s79 offen offset:0 nt
  s_waitcnt vmcnt(8)
  buffer_load_dwordx4 v[68:71], v9, s[72:75], s79 offen offset:256 nt
  s_mov_b32 s83, 1
  s_atomic_add s83, s[42:43], s15 glc
  s_waitcnt vmcnt(8)
  buffer_load_dwordx4 v[72:75], v9, s[72:75], s79 offen offset:2048 nt
  s_waitcnt vmcnt(8)
  buffer_load_dwordx4 v[76:79], v9, s[72:75], s79 offen offset:2304 nt
  s_waitcnt vmcnt(8)
  v_mfma_f32_16x16x32_bf16 v[224:227], v[16:19], v[208:211], 0
  v_mfma_f32_16x16x32_bf16 v[224:227], v[20:23], v[212:215], v[224:227]
  v_mfma_f32_16x16x32_bf16 v[228:231], v[24:27], v[208:211], 0
  v_mfma_f32_16x16x32_bf16 v[228:231], v[28:31], v[212:215], v[228:231]
  s_nop 5
  v_mov_b32_dpp v232, v224 quad_perm:[0,0,0,0] row_mask:0xf bank_mask:0xf
  s_nop 0
  v_mov_b32_dpp v233, v228 quad_perm:[0,0,0,0] row_mask:0xf bank_mask:0xf
  v_add_f32_dpp v232, v225, v232 quad_perm:[1,1,1,1] row_mask:0xf bank_mask:0xf
  s_nop 0
  v_add_f32_dpp v233, v229, v233 quad_perm:[1,1,1,1] row_mask:0xf bank_mask:0xf
  v_add_f32_dpp v232, v226, v232 quad_perm:[2,2,2,2] row_mask:0xf bank_mask:0xf
  s_nop 0
  v_add_f32_dpp v233, v230, v233 quad_perm:[2,2,2,2] row_mask:0xf bank_mask:0xf
  v_add_f32_dpp v232, v227, v232 quad_perm:[3,3,3,3] row_mask:0xf bank_mask:0xf
  s_nop 0
  v_add_f32_dpp v233, v231, v233 quad_perm:[3,3,3,3] row_mask:0xf bank_mask:0xf
  v_cvt_pk_bf16_f32 v249, v232, v233
  v_lshlrev_b32 v232, 16, v249
  v_and_b32 v233, 0xffff0000, v249
  v_max_f32 v234, v232, v233
  v_mov_b32 v249, v234
  s_nop 1
  v_permlane32_swap_b32 v234, v249
  v_max_f32 v234, v234, v249
  v_mov_b32 v249, v234
  s_nop 1
  v_permlane16_swap_b32 v234, v249
  v_max_f32 v234, v234, v249
  v_mul_f32 v234, s13, v234
  v_max_f32 v234, v234, v244
  v_sub_f32 v246, v244, v234
  v_fma_f32 v232, v232, s13, -v234
  v_fma_f32 v233, v233, s13, -v234
  v_exp_f32 v246, v246
  v_exp_f32 v232, v232
  v_exp_f32 v233, v233
  v_mov_b32 v244, v234
  v_fma_f32 v245, v245, v246, v232
  v_mov_b32_dpp v247, v246 row_newbcast:0 row_mask:0x3 bank_mask:0xf
  v_add_f32 v245, v245, v233
  v_cvt_pk_bf16_f32 v232, v232, v232
  v_mov_b32_dpp v247, v246 row_newbcast:8 row_mask:0xc bank_mask:0xf
  v_cvt_pk_bf16_f32 v233, v233, v233
  v_mul_f32 v216, v216, v247
  v_mul_f32 v217, v217, v247
  v_mul_f32 v218, v218, v247
  v_mul_f32 v219, v219, v247
  v_mul_f32 v220, v220, v247
  v_mul_f32 v221, v221, v247
  v_mul_f32 v222, v222, v247
  v_mul_f32 v223, v223, v247
  v_and_b32 v224, v232, v2
  v_and_b32 v225, v232, v3
  v_and_b32 v226, v232, v4
  v_and_b32 v227, v232, v5
  v_and_b32 v228, v233, v2
  v_and_b32 v229, v233, v3
  v_and_b32 v230, v233, v4
  v_and_b32 v231, v233, v5
  v_mfma_f32_16x16x32_bf16 v[216:219], v[224:227], v[32:35], v[216:219]
  v_mfma_f32_16x16x32_bf16 v[220:223], v[224:227], v[36:39], v[220:223]
  v_mfma_f32_16x16x32_bf16 v[216:219], v[228:231], v[40:43], v[216:219]
  v_mfma_f32_16x16x32_bf16 v[220:223], v[228:231], v[44:47], v[220:223]
  s_waitcnt lgkmcnt(0)
  s_mov_b32 s5, s83
  s_cmp_ge_u32 s5, 192
  s_nop 3
  s_cbranch_scc1 Lf1_116
  s_lshl_b32 s5, s5, 12
  s_add_u32 s79, s14, s5
  s_waitcnt vmcnt(8)
  buffer_load_dwordx4 v[16:19], v8, s[68:71], s79 offen offset:0 nt
  s_waitcnt vmcnt(8)
  buffer_load_dwordx4 v[20:23], v8, s[68:71], s79 offen offset:256 nt
  s_waitcnt vmcnt(8)
  buffer_load_dwordx4 v[24:27], v8, s[68:71], s79 offen offset:2048 nt
  s_waitcnt vmcnt(8)
  buffer_load_dwordx4 v[28:31], v8, s[68:71], s79 offen offset:2304 nt
  s_waitcnt vmcnt(8)
  buffer_load_dwordx4 v[32:35], v9, s[72:75], s79 offen offset:0 nt
  s_waitcnt vmcnt(8)
  buffer_load_dwordx4 v[36:39], v9, s[72:75], s79 offen offset:256 nt
  s_mov_b32 s83, 1
  s_atomic_add s83, s[42:43], s15 glc
  s_waitcnt vmcnt(8)
  buffer_load_dwordx4 v[40:43], v9, s[72:75], s79 offen offset:2048 nt
  s_waitcnt vmcnt(8)
  buffer_load_dwordx4 v[44:47], v9, s[72:75], s79 offen offset:2304 nt
  s_waitcnt vmcnt(8)
  v_mfma_f32_16x16x32_bf16 v[224:227], v[48:51], v[208:211], 0
  v_mfma_f32_16x16x32_bf16 v[224:227], v[52:55], v[212:215], v[224:227]
  v_mfma_f32_16x16x32_bf16 v[228:231], v[56:59], v[208:211], 0
  v_mfma_f32_16x16x32_bf16 v[228:231], v[60:63], v[212:215], v[228:231]
  s_nop 5
  v_mov_b32_dpp v232, v224 quad_perm:[0,0,0,0] row_mask:0xf bank_mask:0xf
  s_nop 0
  v_mov_b32_dpp v233, v228 quad_perm:[0,0,0,0] row_mask:0xf bank_mask:0xf
  v_add_f32_dpp v232, v225, v232 quad_perm:[1,1,1,1] row_mask:0xf bank_mask:0xf
  s_nop 0
  v_add_f32_dpp v233, v229, v233 quad_perm:[1,1,1,1] row_mask:0xf bank_mask:0xf
  v_add_f32_dpp v232, v226, v232 quad_perm:[2,2,2,2] row_mask:0xf bank_mask:0xf
  s_nop 0
  v_add_f32_dpp v233, v230, v233 quad_perm:[2,2,2,2] row_mask:0xf bank_mask:0xf
  v_add_f32_dpp v232, v227, v232 quad_perm:[3,3,3,3] row_mask:0xf bank_mask:0xf
  s_nop 0
  v_add_f32_dpp v233, v231, v233 quad_perm:[3,3,3,3] row_mask:0xf bank_mask:0xf
  v_cvt_pk_bf16_f32 v249, v232, v233
  v_lshlrev_b32 v232, 16, v249
  v_and_b32 v233, 0xffff0000, v249
  v_max_f32 v234, v232, v233
  v_mov_b32 v249, v234
  s_nop 1
  v_permlane32_swap_b32 v234, v249
  v_max_f32 v234, v234, v249
  v_mov_b32 v249, v234
  s_nop 1
  v_permlane16_swap_b32 v234, v249
  v_max_f32 v234, v234, v249
  v_mul_f32 v234, s13, v234
  v_max_f32 v234, v234, v244
  v_sub_f32 v246, v244, v234
  v_fma_f32 v232, v232, s13, -v234
  v_fma_f32 v233, v233, s13, -v234
  v_exp_f32 v246, v246
  v_exp_f32 v232, v232
  v_exp_f32 v233, v233
  v_mov_b32 v244, v234
  v_fma_f32 v245, v245, v246, v232
  v_mov_b32_dpp v247, v246 row_newbcast:0 row_mask:0x3 bank_mask:0xf
  v_add_f32 v245, v245, v233
  v_cvt_pk_bf16_f32 v232, v232, v232
  v_mov_b32_dpp v247, v246 row_newbcast:8 row_mask:0xc bank_mask:0xf
  v_cvt_pk_bf16_f32 v233, v233, v233
  v_mul_f32 v216, v216, v247
  v_mul_f32 v217, v217, v247
  v_mul_f32 v218, v218, v247
  v_mul_f32 v219, v219, v247
  v_mul_f32 v220, v220, v247
  v_mul_f32 v221, v221, v247
  v_mul_f32 v222, v222, v247
  v_mul_f32 v223, v223, v247
  v_and_b32 v224, v232, v2
  v_and_b32 v225, v232, v3
  v_and_b32 v226, v232, v4
  v_and_b32 v227, v232, v5
  v_and_b32 v228, v233, v2
  v_and_b32 v229, v233, v3
  v_and_b32 v230, v233, v4
  v_and_b32 v231, v233, v5
  v_mfma_f32_16x16x32_bf16 v[216:219], v[224:227], v[64:67], v[216:219]
  v_mfma_f32_16x16x32_bf16 v[220:223], v[224:227], v[68:71], v[220:223]
  v_mfma_f32_16x16x32_bf16 v[216:219], v[228:231], v[72:75], v[216:219]
  v_mfma_f32_16x16x32_bf16 v[220:223], v[228:231], v[76:79], v[220:223]
  s_nop 6
  s_branch Ld0_114
Ln0_113:
  s_mov_b32 exec_lo, s82
  s_mov_b32 exec_hi, s82
  s_add_u32 s79, s96, 0
  buffer_load_dwordx4 v[112:115], v108, s[60:63], s79 offen offset:0 nt
  s_mov_b64 exec, -1
  s_mov_b32 exec_lo, s82
  s_mov_b32 exec_hi, s82
  s_add_u32 s79, s96, 0
  buffer_load_dwordx4 v[116:119], v108, s[60:63], s79 offen offset:1792 nt
  s_mov_b64 exec, -1
  s_mov_b32 exec_lo, s82
  s_mov_b32 exec_hi, s82
  s_add_u32 s79, s96, 3584
  buffer_load_dwordx4 v[120:123], v108, s[60:63], s79 offen offset:0 nt
  s_mov_b64 exec, -1
  s_mov_b32 exec_lo, s82
  s_mov_b32 exec_hi, s82
  s_add_u32 s79, s96, 3584
  buffer_load_dwordx4 v[124:127], v108, s[60:63], s79 offen offset:1792 nt
  s_mov_b64 exec, -1
  s_mov_b32 exec_lo, s82
  s_mov_b32 exec_hi, s82
  s_add_u32 s79, s96, 7168
  buffer_load_dwordx4 v[128:131], v108, s[60:63], s79 offen offset:0 nt
  s_mov_b64 exec, -1
  s_mov_b32 exec_lo, s82
  s_mov_b32 exec_hi, s82
  s_add_u32 s79, s96, 7168
  buffer_load_dwordx4 v[132:135], v108, s[60:63], s79 offen offset:1792 nt
  s_mov_b64 exec, -1
  s_mov_b32 exec_lo, s82
  s_mov_b32 exec_hi, s82
  s_add_u32 s79, s96, 10752
  buffer_load_dwordx4 v[136:139], v108, s[60:63], s79 offen offset:0 nt
  s_mov_b64 exec, -1
  s_mov_b32 exec_lo, s82
  s_mov_b32 exec_hi, s82
  s_add_u32 s79, s96, 10752
  buffer_load_dwordx4 v[140:143], v108, s[60:63], s79 offen offset:1792 nt
  s_mov_b64 exec, -1
  s_waitcnt vmcnt(14)
  v_and_b32 v224, v238, v2
  v_and_b32 v225, v238, v3
  v_and_b32 v226, v238, v4
  v_and_b32 v227, v238, v5
  s_nop 1
  v_mfma_f32_16x16x32_bf16 v[216:219], v[224:227], v[160:163], v[216:219]
  v_mfma_f32_16x16x32_bf16 v[220:223], v[224:227], v[164:167], v[220:223]
  s_waitcnt vmcnt(12)
  v_and_b32 v228, v239, v2
  v_and_b32 v229, v239, v3
  v_and_b32 v230, v239, v4
  v_and_b32 v231, v239, v5
  s_nop 1
  v_mfma_f32_16x16x32_bf16 v[216:219], v[228:231], v[168:171], v[216:219]
  v_mfma_f32_16x16x32_bf16 v[220:223], v[228:231], v[172:175], v[220:223]
  s_waitcnt vmcnt(10)
  v_and_b32 v224, v240, v2
  v_and_b32 v225, v240, v3
  v_and_b32 v226, v240, v4
  v_and_b32 v227, v240, v5
  s_nop 1
  v_mfma_f32_16x16x32_bf16 v[216:219], v[224:227], v[176:179], v[216:219]
  v_mfma_f32_16x16x32_bf16 v[220:223], v[224:227], v[180:183], v[220:223]
  s_waitcnt vmcnt(8)
  v_and_b32 v228, v241, v2
  v_and_b32 v229, v241, v3
  v_and_b32 v230, v241, v4
  v_and_b32 v231, v241, v5
  s_nop 1
  v_mfma_f32_16x16x32_bf16 v[216:219], v[228:231], v[184:187], v[216:219]
  v_mfma_f32_16x16x32_bf16 v[220:223], v[228:231], v[188:191], v[220:223]
  s_nop 6
  s_branch Lae_112
Lf0_115:
  s_mov_b32 exec_lo, s82
  s_mov_b32 exec_hi, s82
  s_add_u32 s79, s96, 0
  buffer_load_dwordx4 v[112:115], v108, s[60:63], s79 offen offset:0 nt
  s_mov_b64 exec, -1
  s_mov_b32 exec_lo, s82
  s_mov_b32 exec_hi, s82
  s_add_u32 s79, s96, 0
  buffer_load_dwordx4 v[116:119], v108, s[60:63], s79 offen offset:1792 nt
  s_mov_b64 exec, -1
  s_mov_b32 exec_lo, s82
  s_mov_b32 exec_hi, s82
  s_add_u32 s79, s96, 3584
  buffer_load_dwordx4 v[120:123], v108, s[60:63], s79 offen offset:0 nt
  s_mov_b64 exec, -1
  s_mov_b32 exec_lo, s82
  s_mov_b32 exec_hi, s82
  s_add_u32 s79, s96, 3584
  buffer_load_dwordx4 v[124:127], v108, s[60:63], s79 offen offset:1792 nt
  s_mov_b64 exec, -1
  s_mov_b32 exec_lo, s82
  s_mov_b32 exec_hi, s82
  s_add_u32 s79, s96, 7168
  buffer_load_dwordx4 v[128:131], v108, s[60:63], s79 offen offset:0 nt
  s_mov_b64 exec, -1
  s_mov_b32 exec_lo, s82
  s_mov_b32 exec_hi, s82
  s_add_u32 s79, s96, 7168
  buffer_load_dwordx4 v[132:135], v108, s[60:63], s79 offen offset:1792 nt
  s_mov_b64 exec, -1
  s_mov_b32 exec_lo, s82
  s_mov_b32 exec_hi, s82
  s_add_u32 s79, s96, 10752
  buffer_load_dwordx4 v[136:139], v108, s[60:63], s79 offen offset:0 nt
  s_mov_b64 exec, -1
  s_mov_b32 exec_lo, s82
  s_mov_b32 exec_hi, s82
  s_add_u32 s79, s96, 10752
  buffer_load_dwordx4 v[140:143], v108, s[60:63], s79 offen offset:1792 nt
  s_mov_b64 exec, -1
  s_waitcnt vmcnt(12)
  v_mfma_f32_16x16x32_bf16 v[224:227], v[16:19], v[208:211], 0
  v_mfma_f32_16x16x32_bf16 v[224:227], v[20:23], v[212:215], v[224:227]
  v_mfma_f32_16x16x32_bf16 v[228:231], v[24:27], v[208:211], 0
  v_mfma_f32_16x16x32_bf16 v[228:231], v[28:31], v[212:215], v[228:231]
  s_nop 5
  v_mov_b32_dpp v232, v224 quad_perm:[0,0,0,0] row_mask:0xf bank_mask:0xf
  s_nop 0
  v_mov_b32_dpp v233, v228 quad_perm:[0,0,0,0] row_mask:0xf bank_mask:0xf
  v_add_f32_dpp v232, v225, v232 quad_perm:[1,1,1,1] row_mask:0xf bank_mask:0xf
  s_nop 0
  v_add_f32_dpp v233, v229, v233 quad_perm:[1,1,1,1] row_mask:0xf bank_mask:0xf
  v_add_f32_dpp v232, v226, v232 quad_perm:[2,2,2,2] row_mask:0xf bank_mask:0xf
  s_nop 0
  v_add_f32_dpp v233, v230, v233 quad_perm:[2,2,2,2] row_mask:0xf bank_mask:0xf
  v_add_f32_dpp v232, v227, v232 quad_perm:[3,3,3,3] row_mask:0xf bank_mask:0xf
  s_nop 0
  v_add_f32_dpp v233, v231, v233 quad_perm:[3,3,3,3] row_mask:0xf bank_mask:0xf
  v_cvt_pk_bf16_f32 v249, v232, v233
  v_lshlrev_b32 v232, 16, v249
  v_and_b32 v233, 0xffff0000, v249
  v_max_f32 v234, v232, v233
  v_mov_b32 v249, v234
  s_nop 1
  v_permlane32_swap_b32 v234, v249
  v_max_f32 v234, v234, v249
  v_mov_b32 v249, v234
  s_nop 1
  v_permlane16_swap_b32 v234, v249
  v_max_f32 v234, v234, v249
  v_mul_f32 v234, s13, v234
  v_max_f32 v234, v234, v244
  v_sub_f32 v246, v244, v234
  v_fma_f32 v232, v232, s13, -v234
  v_fma_f32 v233, v233, s13, -v234
  v_exp_f32 v246, v246
  v_exp_f32 v232, v232
  v_exp_f32 v233, v233
  v_mov_b32 v244, v234
  v_fma_f32 v245, v245, v246, v232
  v_mov_b32_dpp v247, v246 row_newbcast:0 row_mask:0x3 bank_mask:0xf
  v_add_f32 v245, v245, v233
  v_cvt_pk_bf16_f32 v232, v232, v232
  v_mov_b32_dpp v247, v246 row_newbcast:8 row_mask:0xc bank_mask:0xf
  v_cvt_pk_bf16_f32 v233, v233, v233
  v_mul_f32 v216, v216, v247
  v_mul_f32 v217, v217, v247
  v_mul_f32 v218, v218, v247
  v_mul_f32 v219, v219, v247
  v_mul_f32 v220, v220, v247
  v_mul_f32 v221, v221, v247
  v_mul_f32 v222, v222, v247
  v_mul_f32 v223, v223, v247
  v_and_b32 v224, v232, v2
  v_and_b32 v225, v232, v3
  v_and_b32 v226, v232, v4
  v_and_b32 v227, v232, v5
  v_and_b32 v228, v233, v2
  v_and_b32 v229, v233, v3
  v_and_b32 v230, v233, v4
  v_and_b32 v231, v233, v5
  s_waitcnt vmcnt(8)
  v_mfma_f32_16x16x32_bf16 v[216:219], v[224:227], v[32:35], v[216:219]
  v_mfma_f32_16x16x32_bf16 v[220:223], v[224:227], v[36:39], v[220:223]
  v_mfma_f32_16x16x32_bf16 v[216:219], v[228:231], v[40:43], v[216:219]
  v_mfma_f32_16x16x32_bf16 v[220:223], v[228:231], v[44:47], v[220:223]
  s_nop 6
  s_branch Lae_112
Lf1_116:
  s_mov_b32 exec_lo, s82
  s_mov_b32 exec_hi, s82
  s_add_u32 s79, s96, 0
  buffer_load_dwordx4 v[112:115], v108, s[60:63], s79 offen offset:0 nt
  s_mov_b64 exec, -1
  s_mov_b32 exec_lo, s82
  s_mov_b32 exec_hi, s82
  s_add_u32 s79, s96, 0
  buffer_load_dwordx4 v[116:119], v108, s[60:63], s79 offen offset:1792 nt
  s_mov_b64 exec, -1
  s_mov_b32 exec_lo, s82
  s_mov_b32 exec_hi, s82
  s_add_u32 s79, s96, 3584
  buffer_load_dwordx4 v[120:123], v108, s[60:63], s79 offen offset:0 nt
  s_mov_b64 exec, -1
  s_mov_b32 exec_lo, s82
  s_mov_b32 exec_hi, s82
  s_add_u32 s79, s96, 3584
  buffer_load_dwordx4 v[124:127], v108, s[60:63], s79 offen offset:1792 nt
  s_mov_b64 exec, -1
  s_mov_b32 exec_lo, s82
  s_mov_b32 exec_hi, s82
  s_add_u32 s79, s96, 7168
  buffer_load_dwordx4 v[128:131], v108, s[60:63], s79 offen offset:0 nt
  s_mov_b64 exec, -1
  s_mov_b32 exec_lo, s82
  s_mov_b32 exec_hi, s82
  s_add_u32 s79, s96, 7168
  buffer_load_dwordx4 v[132:135], v108, s[60:63], s79 offen offset:1792 nt
  s_mov_b64 exec, -1
  s_mov_b32 exec_lo, s82
  s_mov_b32 exec_hi, s82
  s_add_u32 s79, s96, 10752
  buffer_load_dwordx4 v[136:139], v108, s[60:63], s79 offen offset:0 nt
  s_mov_b64 exec, -1
  s_mov_b32 exec_lo, s82
  s_mov_b32 exec_hi, s82
  s_add_u32 s79, s96, 10752
  buffer_load_dwordx4 v[140:143], v108, s[60:63], s79 offen offset:1792 nt
  s_mov_b64 exec, -1
  s_waitcnt vmcnt(12)
  v_mfma_f32_16x16x32_bf16 v[224:227], v[48:51], v[208:211], 0
  v_mfma_f32_16x16x32_bf16 v[224:227], v[52:55], v[212:215], v[224:227]
  v_mfma_f32_16x16x32_bf16 v[228:231], v[56:59], v[208:211], 0
  v_mfma_f32_16x16x32_bf16 v[228:231], v[60:63], v[212:215], v[228:231]
  s_nop 5
  v_mov_b32_dpp v232, v224 quad_perm:[0,0,0,0] row_mask:0xf bank_mask:0xf
  s_nop 0
  v_mov_b32_dpp v233, v228 quad_perm:[0,0,0,0] row_mask:0xf bank_mask:0xf
  v_add_f32_dpp v232, v225, v232 quad_perm:[1,1,1,1] row_mask:0xf bank_mask:0xf
  s_nop 0
  v_add_f32_dpp v233, v229, v233 quad_perm:[1,1,1,1] row_mask:0xf bank_mask:0xf
  v_add_f32_dpp v232, v226, v232 quad_perm:[2,2,2,2] row_mask:0xf bank_mask:0xf
  s_nop 0
  v_add_f32_dpp v233, v230, v233 quad_perm:[2,2,2,2] row_mask:0xf bank_mask:0xf
  v_add_f32_dpp v232, v227, v232 quad_perm:[3,3,3,3] row_mask:0xf bank_mask:0xf
  s_nop 0
  v_add_f32_dpp v233, v231, v233 quad_perm:[3,3,3,3] row_mask:0xf bank_mask:0xf
  v_cvt_pk_bf16_f32 v249, v232, v233
  v_lshlrev_b32 v232, 16, v249
  v_and_b32 v233, 0xffff0000, v249
  v_max_f32 v234, v232, v233
  v_mov_b32 v249, v234
  s_nop 1
  v_permlane32_swap_b32 v234, v249
  v_max_f32 v234, v234, v249
  v_mov_b32 v249, v234
  s_nop 1
  v_permlane16_swap_b32 v234, v249
  v_max_f32 v234, v234, v249
  v_mul_f32 v234, s13, v234
  v_max_f32 v234, v234, v244
  v_sub_f32 v246, v244, v234
  v_fma_f32 v232, v232, s13, -v234
  v_fma_f32 v233, v233, s13, -v234
  v_exp_f32 v246, v246
  v_exp_f32 v232, v232
  v_exp_f32 v233, v233
  v_mov_b32 v244, v234
  v_fma_f32 v245, v245, v246, v232
  v_mov_b32_dpp v247, v246 row_newbcast:0 row_mask:0x3 bank_mask:0xf
  v_add_f32 v245, v245, v233
  v_cvt_pk_bf16_f32 v232, v232, v232
  v_mov_b32_dpp v247, v246 row_newbcast:8 row_mask:0xc bank_mask:0xf
  v_cvt_pk_bf16_f32 v233, v233, v233
  v_mul_f32 v216, v216, v247
  v_mul_f32 v217, v217, v247
  v_mul_f32 v218, v218, v247
  v_mul_f32 v219, v219, v247
  v_mul_f32 v220, v220, v247
  v_mul_f32 v221, v221, v247
  v_mul_f32 v222, v222, v247
  v_mul_f32 v223, v223, v247
  v_and_b32 v224, v232, v2
  v_and_b32 v225, v232, v3
  v_and_b32 v226, v232, v4
  v_and_b32 v227, v232, v5
  v_and_b32 v228, v233, v2
  v_and_b32 v229, v233, v3
  v_and_b32 v230, v233, v4
  v_and_b32 v231, v233, v5
  s_waitcnt vmcnt(8)
  v_mfma_f32_16x16x32_bf16 v[216:219], v[224:227], v[64:67], v[216:219]
  v_mfma_f32_16x16x32_bf16 v[220:223], v[224:227], v[68:71], v[220:223]
  v_mfma_f32_16x16x32_bf16 v[216:219], v[228:231], v[72:75], v[216:219]
  v_mfma_f32_16x16x32_bf16 v[220:223], v[228:231], v[76:79], v[220:223]
Lae_112:
  v_mov_b32 v249, v245
  s_nop 1
  v_permlane32_swap_b32 v245, v249
  v_add_f32 v245, v245, v249
  v_mov_b32 v249, v245
  s_nop 1
  v_permlane16_swap_b32 v245, v249
  v_add_f32 v245, v245, v249
  ds_write_b64 v15, v[244:245] offset:2048
  ds_write_b128 v12, v[216:219] offset:4096
  ds_write_b128 v12, v[220:223] offset:5120
  s_waitcnt lgkmcnt(0)
  s_barrier
  ds_read_b128 v[92:95], v13 offset:2048
  ds_read_b128 v[96:99], v13 offset:2064
  ds_read_b64 v[84:85], v83 offset:4096
  ds_read_b64 v[86:87], v83 offset:6144
  ds_read_b64 v[88:89], v83 offset:8192
  ds_read_b64 v[90:91], v83 offset:10240
  s_waitcnt lgkmcnt(4)
  v_max3_f32 v104, v92, v94, v96
  v_max_f32 v104, v104, v98
  v_sub_f32 v92, v92, v104
  v_sub_f32 v94, v94, v104
  v_sub_f32 v96, v96, v104
  v_sub_f32 v98, v98, v104
  v_exp_f32 v92, v92
  v_exp_f32 v94, v94
  v_exp_f32 v96, v96
  v_exp_f32 v98, v98
  s_waitcnt lgkmcnt(0)
  v_mul_f32 v100, v92, v84
  v_mul_f32 v102, v92, v85
  v_fmac_f32 v100, v94, v86
  v_fmac_f32 v102, v94, v87
  v_fmac_f32 v100, v96, v88
  v_fmac_f32 v102, v96, v89
  v_fmac_f32 v100, v98, v90
  v_fmac_f32 v102, v98, v91
  buffer_store_dwordx4 v[100:103], v82, s[44:47], s12 offen sc1
  s_bitcmp1_b32 s3, 0
  s_cbranch_scc1 Lax_117
  v_mul_f32 v106, v92, v93
  v_fmac_f32 v106, v94, v95
  v_fmac_f32 v106, v96, v97
  v_fmac_f32 v106, v98, v99
  s_mov_b32 exec_lo, 0x1
  s_mov_b32 exec_hi, 0x0
  buffer_store_dwordx4 v[104:107], v254, s[44:47], s10 offen sc1
  s_mov_b64 exec, -1
Lax_117:
  s_cmp_ge_u32 s11, 128
  s_cbranch_scc1 L_afin
  s_lshr_b32 s12, s97, 3
  v_lshrrev_b32 v230, 4, v1
  v_lshlrev_b32 v230, 7, v230
  s_lshr_b32 s8, s12, 1
  s_lshl_b32 s8, s8, 12
  s_and_b32 s6, s12, 1
  s_lshl_b32 s6, s6, 4
  s_add_u32 s8, s8, s6
  s_lshl_b32 s6, s3, 10
  s_add_u32 s8, s8, s6
  s_add_u32 s8, s8, 229376
  s_mul_i32 s6, s97, 8320
  s_lshl_b32 s5, s3, 11
  s_add_u32 s6, s6, s5
  s_add_u32 s6, s6, 524288
  v_lshlrev_b32 v228, 4, v0
  s_mul_i32 s15, s97, 4224
  s_lshl_b32 s5, s3, 10
  s_add_u32 s15, s15, s5
  s_add_u32 s15, s15, 2097152
  s_mov_b32 s78, 2000
  s_add_u32 s64, s6, 4
  s_add_u32 s65, s6, 516
  s_add_u32 s66, s6, 1028
Lsp_118:
  s_load_dword s68, s[42:43], s64 glc
  s_load_dword s69, s[42:43], s65 glc
  s_load_dword s70, s[42:43], s66 glc
  s_waitcnt lgkmcnt(0)
  s_mov_b32 s83, 0
  s_cmp_eq_u32 s68, s76
  s_addc_u32 s83, s83, 0
  s_cmp_eq_u32 s69, s76
  s_addc_u32 s83, s83, 0
  s_cmp_eq_u32 s70, s76
  s_addc_u32 s83, s83, 0
  s_cmp_ge_u32 s83, 3
  s_cbranch_scc1 Lspd_119
  s_sleep 2
  s_sub_u32 s78, s78, 1
  s_cmp_lg_u32 s78, 0
  s_cbranch_scc1 Lsp_118
Lspd_119:
  s_mov_b32 s78, 100000
Lpoll_120:
  buffer_load_dwordx4 v[16:19], v6, s[44:47], s6 offen sc1
  buffer_load_dwordx4 v[20:23], v6, s[44:47], s6 offen offset:1024 sc1
  buffer_load_dwordx4 v[24:27], v230, s[44:47], s8 offen sc1
  buffer_load_dwordx4 v[28:31], v230, s[44:47], s8 offen offset:512 sc1
Lpw_121:
  s_waitcnt vmcnt(0)
  v_bitop3_b32 v32, v17, v19, s76 bitop3:0x7e
  v_bitop3_b32 v33, v21, v23, s76 bitop3:0x7e
  v_bitop3_b32 v25, v25, v27, s76 bitop3:0x7e
  v_bitop3_b32 v29, v29, v31, s76 bitop3:0x7e
  v_or3_b32 v32, v32, v33, v25
  v_or3_b32 v32, v32, v29, v29
  v_cmp_ne_u32 vcc, 0, v32
  s_nop 0
  s_cmp_eq_u64 vcc, 0
  s_nop 1
  s_cbranch_scc1 Lpd_122
  s_sleep 2
  s_sub_u32 s78, s78, 1
  s_cmp_lg_u32 s78, 0
  s_cbranch_scc1 Lpoll_120
Lpd_122:
  v_max_f32 v34, v24, v28
  v_sub_f32 v24, v24, v34
  v_sub_f32 v28, v28, v34
  v_exp_f32 v24, v24
  v_exp_f32 v28, v28
  v_mul_f32 v32, v24, v16
  v_mul_f32 v33, v24, v18
  v_mul_f32 v35, v24, v26
  v_fmac_f32 v32, v28, v20
  v_fmac_f32 v33, v28, v22
  v_fmac_f32 v35, v28, v30
  ds_write_b128 v228, v[32:35] offset:24576
  s_waitcnt lgkmcnt(0)
  s_barrier
  ds_read_b128 v[16:19], v6 offset:24576
  ds_read_b128 v[20:23], v6 offset:25600
  ds_read_b128 v[24:27], v6 offset:26624
  ds_read_b128 v[28:31], v6 offset:27648
  s_waitcnt lgkmcnt(0)
  v_max3_f32 v34, v18, v22, v26
  v_max_f32 v34, v34, v30
  v_mov_b32 v36, v34
  s_nop 1
  v_permlane32_swap_b32 v34, v36
  v_max_f32 v34, v34, v36
  v_mov_b32 v36, v34
  s_nop 1
  v_permlane16_swap_b32 v34, v36
  v_max_f32 v34, v34, v36
  v_sub_f32 v18, v18, v34
  v_sub_f32 v22, v22, v34
  v_sub_f32 v26, v26, v34
  v_sub_f32 v30, v30, v34
  v_exp_f32 v18, v18
  v_exp_f32 v22, v22
  v_exp_f32 v26, v26
  v_exp_f32 v30, v30
  v_mul_f32 v35, v18, v19
  v_mul_f32 v32, v18, v16
  v_mul_f32 v33, v18, v17
  v_fmac_f32 v35, v22, v23
  v_fmac_f32 v32, v22, v20
  v_fmac_f32 v33, v22, v21
  v_fmac_f32 v35, v26, v27
  v_fmac_f32 v32, v26, v24
  v_fmac_f32 v33, v26, v25
  v_fmac_f32 v35, v30, v31
  v_fmac_f32 v32, v30, v28
  v_fmac_f32 v33, v30, v29
  v_mov_b32 v36, v35
  s_nop 1
  v_permlane32_swap_b32 v35, v36
  v_add_f32 v35, v35, v36
  v_mov_b32 v36, v35
  s_nop 1
  v_permlane16_swap_b32 v35, v36
  v_add_f32 v35, v35, v36
  v_rcp_f32 v35, v35
  v_permlane32_swap_b32 v32, v33
  v_add_f32 v32, v32, v33
  v_mov_b32 v33, v32
  s_nop 1
  v_permlane16_swap_b32 v32, v33
  v_add_f32 v32, v32, v33
  v_mul_f32 v32, v32, v35
  v_cvt_pk_bf16_f32 v32, v32, v32
  v_mov_b32 v33, v32
  s_nop 1
  v_mov_b32_dpp v32, v33 row_ror:8 row_mask:0xa bank_mask:0xf
  s_nop 1
  v_and_b32_dpp v232, v32, v2 row_newbcast:0 row_mask:0xf bank_mask:0xf
  v_and_b32_dpp v233, v32, v3 row_newbcast:0 row_mask:0xf bank_mask:0xf
  v_and_b32_dpp v234, v32, v4 row_newbcast:0 row_mask:0xf bank_mask:0xf
  v_and_b32_dpp v235, v32, v5 row_newbcast:0 row_mask:0xf bank_mask:0xf
  s_nop 1
  v_mfma_f32_16x16x32_bf16 v[240:243], v[232:235], v[112:115], 0
  v_and_b32_dpp v236, v32, v2 row_newbcast:1 row_mask:0xf bank_mask:0xf
  v_and_b32_dpp v237, v32, v3 row_newbcast:1 row_mask:0xf bank_mask:0xf
  v_and_b32_dpp v238, v32, v4 row_newbcast:1 row_mask:0xf bank_mask:0xf
  v_and_b32_dpp v239, v32, v5 row_newbcast:1 row_mask:0xf bank_mask:0xf
  s_nop 1
  v_mfma_f32_16x16x32_bf16 v[240:243], v[236:239], v[116:119], v[240:243]
  v_and_b32_dpp v232, v32, v2 row_newbcast:2 row_mask:0xf bank_mask:0xf
  v_and_b32_dpp v233, v32, v3 row_newbcast:2 row_mask:0xf bank_mask:0xf
  v_and_b32_dpp v234, v32, v4 row_newbcast:2 row_mask:0xf bank_mask:0xf
  v_and_b32_dpp v235, v32, v5 row_newbcast:2 row_mask:0xf bank_mask:0xf
  s_nop 1
  v_mfma_f32_16x16x32_bf16 v[240:243], v[232:235], v[120:123], v[240:243]
  v_and_b32_dpp v236, v32, v2 row_newbcast:3 row_mask:0xf bank_mask:0xf
  v_and_b32_dpp v237, v32, v3 row_newbcast:3 row_mask:0xf bank_mask:0xf
  v_and_b32_dpp v238, v32, v4 row_newbcast:3 row_mask:0xf bank_mask:0xf
  v_and_b32_dpp v239, v32, v5 row_newbcast:3 row_mask:0xf bank_mask:0xf
  s_nop 1
  v_mfma_f32_16x16x32_bf16 v[240:243], v[236:239], v[124:127], v[240:243]
  v_and_b32_dpp v232, v32, v2 row_newbcast:4 row_mask:0xf bank_mask:0xf
  v_and_b32_dpp v233, v32, v3 row_newbcast:4 row_mask:0xf bank_mask:0xf
  v_and_b32_dpp v234, v32, v4 row_newbcast:4 row_mask:0xf bank_mask:0xf
  v_and_b32_dpp v235, v32, v5 row_newbcast:4 row_mask:0xf bank_mask:0xf
  s_nop 1
  v_mfma_f32_16x16x32_bf16 v[240:243], v[232:235], v[128:131], v[240:243]
  v_and_b32_dpp v236, v32, v2 row_newbcast:5 row_mask:0xf bank_mask:0xf
  v_and_b32_dpp v237, v32, v3 row_newbcast:5 row_mask:0xf bank_mask:0xf
  v_and_b32_dpp v238, v32, v4 row_newbcast:5 row_mask:0xf bank_mask:0xf
  v_and_b32_dpp v239, v32, v5 row_newbcast:5 row_mask:0xf bank_mask:0xf
  s_nop 1
  v_mfma_f32_16x16x32_bf16 v[240:243], v[236:239], v[132:135], v[240:243]
  v_and_b32_dpp v232, v32, v2 row_newbcast:6 row_mask:0xf bank_mask:0xf
  v_and_b32_dpp v233, v32, v3 row_newbcast:6 row_mask:0xf bank_mask:0xf
  v_and_b32_dpp v234, v32, v4 row_newbcast:6 row_mask:0xf bank_mask:0xf
  v_and_b32_dpp v235, v32, v5 row_newbcast:6 row_mask:0xf bank_mask:0xf
  s_nop 1
  v_mfma_f32_16x16x32_bf16 v[240:243], v[232:235], v[136:139], v[240:243]
  v_and_b32_dpp v236, v32, v2 row_newbcast:7 row_mask:0xf bank_mask:0xf
  v_and_b32_dpp v237, v32, v3 row_newbcast:7 row_mask:0xf bank_mask:0xf
  v_and_b32_dpp v238, v32, v4 row_newbcast:7 row_mask:0xf bank_mask:0xf
  v_and_b32_dpp v239, v32, v5 row_newbcast:7 row_mask:0xf bank_mask:0xf
  s_nop 1
  v_mfma_f32_16x16x32_bf16 v[240:243], v[236:239], v[140:143], v[240:243]
  v_cmp_gt_u32 vcc, 32, v1
  v_mov_b32 v245, s76
  v_mov_b32 v247, s76
  s_mov_b32 exec_lo, s82
  s_mov_b32 exec_hi, s82
  s_nop 2
  v_cndmask_b32 v244, v242, v240, vcc
  v_cndmask_b32 v246, v243, v241, vcc
  buffer_store_dwordx4 v[244:247], v6, s[44:47], s15 offen sc1
  s_mov_b64 exec, -1
  s_branch L_aend
L_afin:
  s_sub_u32 s97, 127, s97
  s_cmp_ge_u32 s97, 56
  s_cbranch_scc1 L_aend
  s_cmp_ge_u32 s3, 1
  s_cbranch_scc1 L_aend
  s_mov_b32 s52, s38
  s_mov_b32 s53, s39
  s_mov_b32 s54, 1792
  s_mov_b32 s55, 0x20000
  s_mov_b32 s12, 0
  s_mov_b32 s13, s97
  s_sub_u32 s5, s13, 48
  s_lshr_b32 s6, s5, 1
  s_lshl_b32 s6, s6, 2
  s_and_b32 s5, s5, 1
  s_add_u32 s6, s6, s5
  s_add_u32 s6, s6, 48
  s_cmp_ge_u32 s13, 48
  s_cselect_b32 s13, s6, s13
  s_mul_i32 s6, s12, 540672
  s_lshl_b32 s5, s13, 6
  s_add_u32 s6, s6, s5
  s_add_u32 s6, s6, 2097152
  v_lshrrev_b32 v217, 2, v1
  v_mul_u32_u24 v217, 4224, v217
  v_and_b32 v218, 3, v1
  v_lshl_add_u32 v217, v218, 4, v217
  s_mul_i32 s15, s12, 896
  s_lshr_b32 s5, s13, 4
  s_lshl_b32 s5, s5, 8
  s_add_u32 s15, s15, s5
  s_and_b32 s5, s13, 3
  s_lshl_b32 s5, s5, 6
  s_add_u32 s15, s15, s5
  s_bfe_u32 s5, s13, 0x10002
  s_lshl_b32 s5, s5, 3
  s_add_u32 s15, s15, s5
  s_bfe_u32 s5, s13, 0x10003
  s_lshl_b32 s5, s5, 2
  s_add_u32 s15, s15, s5
  v_lshlrev_b32 v216, 2, v1
  s_mov_b32 s78, 2000
  s_add_u32 s64, s6, 4
  s_add_u32 s65, s6, 156292
  s_add_u32 s66, s6, 312580
Lsp_123:
  s_load_dword s68, s[42:43], s64 glc
  s_load_dword s69, s[42:43], s65 glc
  s_load_dword s70, s[42:43], s66 glc
  s_waitcnt lgkmcnt(0)
  s_mov_b32 s83, 0
  s_cmp_eq_u32 s68, s76
  s_addc_u32 s83, s83, 0
  s_cmp_eq_u32 s69, s76
  s_addc_u32 s83, s83, 0
  s_cmp_eq_u32 s70, s76
  s_addc_u32 s83, s83, 0
  s_cmp_ge_u32 s83, 3
  s_cbranch_scc1 Lspd_124
  s_sleep 2
  s_sub_u32 s78, s78, 1
  s_cmp_lg_u32 s78, 0
  s_cbranch_scc1 Lsp_123
Lspd_124:
  s_mov_b32 s78, 100000
Lpoll_125:
  s_add_u32 s79, s6, 0
  buffer_load_dwordx4 v[16:19], v217, s[44:47], s79 offen sc1
  s_add_u32 s79, s6, 67584
  buffer_load_dwordx4 v[20:23], v217, s[44:47], s79 offen sc1
  s_add_u32 s79, s6, 135168
  buffer_load_dwordx4 v[24:27], v217, s[44:47], s79 offen sc1
  s_add_u32 s79, s6, 202752
  buffer_load_dwordx4 v[28:31], v217, s[44:47], s79 offen sc1
  s_add_u32 s79, s6, 270336
  buffer_load_dwordx4 v[32:35], v217, s[44:47], s79 offen sc1
  s_add_u32 s79, s6, 337920
  buffer_load_dwordx4 v[36:39], v217, s[44:47], s79 offen sc1
  s_add_u32 s79, s6, 405504
  buffer_load_dwordx4 v[40:43], v217, s[44:47], s79 offen sc1
  s_add_u32 s79, s6, 473088
  buffer_load_dwordx4 v[44:47], v217, s[44:47], s79 offen sc1
Lpw_126:
  s_waitcnt vmcnt(0)
  v_bitop3_b32 v212, v17, v19, s76 bitop3:0x7e
  v_bitop3_b32 v213, v21, v23, s76 bitop3:0x7e
  v_bitop3_b32 v25, v25, v27, s76 bitop3:0x7e
  v_bitop3_b32 v29, v29, v31, s76 bitop3:0x7e
  v_bitop3_b32 v33, v33, v35, s76 bitop3:0x7e
  v_bitop3_b32 v37, v37, v39, s76 bitop3:0x7e
  v_bitop3_b32 v41, v41, v43, s76 bitop3:0x7e
  v_bitop3_b32 v45, v45, v47, s76 bitop3:0x7e
  v_or3_b32 v212, v212, v213, v25
  v_or3_b32 v212, v212, v29, v33
  v_or3_b32 v212, v212, v37, v41
  v_or3_b32 v212, v212, v45, v45
  v_cmp_ne_u32 vcc, 0, v212
  s_nop 0
  s_cmp_eq_u64 vcc, 0
  s_nop 1
  s_cbranch_scc1 Lpd_127
  s_sleep 2
  s_sub_u32 s78, s78, 1
  s_cmp_lg_u32 s78, 0
  s_cbranch_scc1 Lpoll_125
Lpd_127:
  v_add_f32 v16, v16, v32
  v_add_f32 v18, v18, v34
  v_add_f32 v20, v20, v36
  v_add_f32 v22, v22, v38
  v_add_f32 v24, v24, v40
  v_add_f32 v26, v26, v42
  v_add_f32 v28, v28, v44
  v_add_f32 v30, v30, v46
  v_add_f32 v16, v16, v24
  v_add_f32 v18, v18, v26
  v_add_f32 v20, v20, v28
  v_add_f32 v22, v22, v30
  v_add_f32 v16, v16, v20
  v_add_f32 v18, v18, v22
  s_nop 0
  v_add_f32_dpp v16, v16, v16 row_ror:8 row_mask:0xf bank_mask:0xf
  v_add_f32_dpp v18, v18, v18 row_ror:8 row_mask:0xf bank_mask:0xf
  s_nop 0
  v_add_f32_dpp v16, v16, v16 row_ror:4 row_mask:0xf bank_mask:0xf
  v_add_f32_dpp v18, v18, v18 row_ror:4 row_mask:0xf bank_mask:0xf
  v_mov_b32 v17, v16
  s_nop 1
  v_permlane32_swap_b32 v16, v17
  v_add_f32 v16, v16, v17
  v_mov_b32 v17, v16
  s_nop 1
  v_permlane16_swap_b32 v16, v17
  v_add_f32 v16, v16, v17
  v_mov_b32 v19, v18
  s_nop 1
  v_permlane32_swap_b32 v18, v19
  v_add_f32 v18, v18, v19
  v_mov_b32 v19, v18
  s_nop 1
  v_permlane16_swap_b32 v18, v19
  v_add_f32 v18, v18, v19
  v_cvt_pk_bf16_f32 v16, v16, v18
  s_mov_b32 exec_lo, 0xf
  s_mov_b32 exec_hi, 0x0
  buffer_store_dword v16, v6, s[52:55], s15 offen
  s_mov_b64 exec, -1
L_aend:
  s_endpgm
L_end:
  s_endpgm
.section .rodata,"a"
.p2align 6
.amdhsa_kernel concat_heads__gqa_block_cached__compressed_kv_cla__decode_kernel
  .amdhsa_next_free_vgpr 256
  .amdhsa_next_free_sgpr 102
  .amdhsa_accum_offset 256
  .amdhsa_group_segment_fixed_size 0
  .amdhsa_kernarg_size 112
  .amdhsa_user_sgpr_count 2
  .amdhsa_user_sgpr_kernarg_segment_ptr 1
  .amdhsa_system_sgpr_workgroup_id_x 1
.end_amdhsa_kernel
```
